```python
import torch

def _softmax(x, axis=-1):
    return torch.softmax(x, dim=axis)
def _gelu(x):
    return torch.nn.functional.gelu(x, approximate="tanh")
def _silu(x):
    return torch.nn.functional.silu(x)
def _sigmoid(x):
    return torch.sigmoid(x)
def _layernorm(x, axis=-1, eps=1e-5):
    m = x.mean(dim=axis, keepdim=True)
    v = x.var(dim=axis, keepdim=True, unbiased=False)
    return (x - m) / torch.sqrt(v + eps)
def _scatter_add(tgt, idx, src, axis=0):
    return tgt.clone().index_add_(axis, idx, src)
def _segment_sum(src, seg, n):
    out = torch.zeros((n,) + src.shape[1:], dtype=src.dtype)
    return out.index_add_(0, seg, src)
def _pad(x, pw):
    flat = tuple(v for pair in reversed(pw) for v in pair)
    return torch.nn.functional.pad(x, flat)

kernel_name = 'standalone__weight_only_int_quip__prompt'

def setup_inputs():

    _w = (lambda a: (lambda t: t.to(torch.bfloat16) if t.is_floating_point() else t)(torch.as_tensor(a)))
    B, S, D, F = 1, 2048, 640, 1536
    G = 32 if 32 > 0 else D
    D = (D // G) * G
    ng = D // G
    bits = 3 if 3 > 0 else 4
    qmax = 1 << bits
    qw = torch.randint(0, qmax, (D, F)).to(torch.int32)
    U, _ = (lambda *_a, **_k: torch.linalg.qr(*[torch.as_tensor(_x).float() for _x in _a], **_k))((lambda *s: torch.randn(*s, dtype=torch.bfloat16) * 0.05)(D, D))
    V, _ = (lambda *_a, **_k: torch.linalg.qr(*[torch.as_tensor(_x).float() for _x in _a], **_k))((lambda *s: torch.randn(*s, dtype=torch.bfloat16) * 0.05)(F, F))
    return {
        "x": _w((lambda *s: torch.randn(*s, dtype=torch.bfloat16) * 0.05)(B, S, D)),
        "qw": _w(qw),
        "scales": _w(torch.abs((lambda *s: torch.randn(*s, dtype=torch.bfloat16) * 0.05)(ng, F)) * 0.02 + 0.005),
        "zeros": _w(torch.full((ng, F), qmax / 2.0, dtype=float)),
        "U": _w(U.to(float)),
        "V": _w(V.to(float)),
    }

def reference(x, qw, scales, zeros, U, V):
    B, S, D = x.shape
    ng, F = scales.shape
    G = D // ng
    s = (lambda x, n, axis: torch.repeat_interleave(x, n, dim=axis))(scales, G, axis=0)
    z = (lambda x, n, axis: torch.repeat_interleave(x, n, dim=axis))(zeros, G, axis=0)
    wq = ((lambda x, dt: x.to(dt))(qw, x.dtype) - z) * s
    xr = torch.einsum("bsd,de->bse", x, U)
    h  = torch.einsum("bse,ef->bsf", xr, wq)
    y  = torch.einsum("bsf,fg->bsg", h, V)
    return y
```

```asm
; @launch grid=(256,1,1) block=(256,1,1) lds=159744
.amdgcn_target "amdgcn-amd-amdhsa--gfx950"
.text
.globl standalone__weight_only_int_quip__prompt_kernel
.p2align 8
.type standalone__weight_only_int_quip__prompt_kernel,@function
standalone__weight_only_int_quip__prompt_kernel:
    s_cmp_ge_u32 s2, 256
    s_cbranch_scc1 L_exit
    s_load_dwordx8 s[4:11], s[0:1], 0
    s_load_dwordx8 s[12:19], s[0:1], 32
    s_load_dwordx2 s[20:21], s[0:1], 64
    s_add_u32 s56, s2, 96
    s_bfe_u32 s56, s56, 0x50003
    v_and_b32 v1, 63, v0
    v_lshrrev_b32 v2, 6, v0
    v_and_b32 v3, 15, v1
    v_readfirstlane_b32 s3, v2
    v_lshrrev_b32 v2, 4, v1
    s_getpc_b64 s[60:61]
L_pc:
    v_subrev_u32 v5, 64, v0
    v_lshl_add_u32 v6, s56, 4, v5
    v_lshlrev_b32 v6, 7, v6
    v_cmp_gt_u32 vcc, 16, v5
    s_mov_b32 s62, L_code_end-L_pc
    v_cmp_gt_u32 s[64:65], s62, v6
    s_and_b64 exec, vcc, s[64:65]
    global_load_dword v95, v6, s[60:61]
    s_mov_b64 exec, -1
    s_bfe_u32 s22, s2, 0x20001
    s_and_b32 s23, s2, 1
    v_lshlrev_b32 v4, 4, v1
    v_lshrrev_b32 v5, 3, v1
    v_bfe_u32 v6, v1, 1, 2
    v_xor_b32 v6, v6, v2
    v_lshlrev_b32 v6, 5, v6
    v_and_b32 v7, 1, v1
    v_lshl_add_u32 v6, v7, 4, v6
    s_mov_b32 s38, 178388992
    s_mov_b32 s39, 0x00020000
    s_mov_b32 s26, 2621440
    s_mov_b32 s27, 0x00020000
    s_mov_b32 s30, 819200
    s_mov_b32 s31, 0x00020000
    v_mov_b32 v20, 1
    s_cmp_lg_u32 s56, 20
    s_cbranch_scc1 L_nc
    s_and_b32 s75, s2, 7
    s_lshl3_add_u32 s75, s3, s75
    s_cmp_ge_u32 s75, 16
    s_cbranch_scc1 L_nc
    s_mul_i32 s74, s75, 8192
    s_add_u32 s74, s74, 178257920
    v_mov_b32 v32, 0
    v_mov_b32 v33, 0
    v_mov_b32 v34, 0
    v_mov_b32 v35, 0
    v_lshlrev_b32 v36, 2, v1
    v_and_b32 v37, 0x3c0, v4
    v_add_u32 v37, v37, v4
    s_mul_i32 s75, s75, 1
    s_waitcnt lgkmcnt(0)
    s_mov_b32 s36, s20
    s_and_b32 s37, s21, 0xffff
    s_mov_b64 exec, 1
    global_load_dword v94, v32, s[18:19] offset:128 sc1
    s_mov_b64 exec, -1
    buffer_store_dwordx4 v[32:35], v37, s[36:39], s74 offen offset:0 sc1
    buffer_store_dwordx4 v[32:35], v37, s[36:39], s74 offen offset:2048 sc1
    s_add_u32 s74, s74, 4096
    buffer_store_dwordx4 v[32:35], v37, s[36:39], s74 offen offset:0 sc1
    buffer_store_dwordx4 v[32:35], v37, s[36:39], s74 offen offset:2048 sc1
    s_bfm_b64 exec, 1, s75
    s_waitcnt vmcnt(0)
    global_store_dword v36, v20, s[18:19] sc1
    s_mov_b64 exec, -1
L_nc:
    s_cmp_lt_u32 s56, 24
    s_cbranch_scc1 L_trole
L_xrole:
    s_mul_i32 s92, s3, 9216
    s_sub_u32 s57, s56, 24
    s_and_b32 s58, s57, 3
    s_lshl_b32 s67, s22, 2
    s_add_u32 s67, s67, s58
    s_lshl_b32 s62, s57, 2
    s_lshr_b32 s62, 0x0, s62
    s_and_b32 s62, s62, 15
    s_lshl_b32 s63, s67, 2
    s_add_u32 s63, s63, s3
    s_mul_i32 s63, s63, 40960
    s_lshl_b32 s65, s62, 7
    s_add_u32 s76, s65, s63
    s_add_u32 s77, s63, 1280
    v_and_b32 v0, 7, v1
    v_xor_b32 v0, v0, v5
    v_mul_u32_u24 v232, 1280, v5
    v_lshl_add_u32 v232, v0, 4, v232
    v_add_u32 v233, 9216, v232
    v_add_u32 v234, 18432, v232
    v_add_u32 v235, 27648, v232
    s_waitcnt lgkmcnt(0)
    s_mov_b32 s24, s4
    s_and_b32 s25, s5, 0xffff
    s_add_u32 m0, s92, 0
    s_nop 0
    buffer_load_dwordx4 v232, s[24:27], s76 offen offset:0 lds
    buffer_load_dwordx4 v233, s[24:27], s76 offen offset:1024 lds
    buffer_load_dwordx4 v234, s[24:27], s76 offen offset:2048 lds
    buffer_load_dwordx4 v235, s[24:27], s76 offen offset:3072 lds
    s_branch L_xbody
L_trole:
    s_mul_i32 s92, s3, 28672
    s_and_b32 s57, s22, 1
    s_lshl_b32 s58, s23, 1
    s_add_u32 s57, s57, s58
    s_lshr_b32 s58, s22, 1
    s_and_b32 s59, s56, 3
    s_mov_b32 s78, s58
    s_lshr_b32 s67, s56, 2
    s_mul_i32 s60, s57, 6
    s_add_u32 s60, s60, s67
    s_lshl_b32 s89, s56, 2
    s_and_b32 s89, s89, 28
    s_xor_b32 s64, s3, s56
    s_bitcmp1_b32 s64, 1
    s_cbranch_scc1 L_tch
    s_mul_i32 s62, s56, 52
    s_lshr_b32 s62, s62, 8
    s_mul_i32 s63, s62, 5
    s_sub_u32 s63, s56, s63
    s_mul_i32 s64, s78, 5
    s_add_u32 s63, s63, s64
    s_lshl2_add_u32 s62, s57, s62
    s_and_b32 s61, s3, 1
    s_lshl1_add_u32 s61, s63, s61
    s_mul_i32 s70, s61, 196608
    s_mul_i32 s72, s62, 192
    s_lshl1_add_u32 s70, s72, s70
    s_mul_i32 s71, s61, 3072
    s_add_u32 s71, s71, s72
    s_cmp_ge_u32 s56, 20
    s_cselect_b32 s70, 0x1000000, s70
    s_cselect_b32 s71, 0x1000000, s71
    v_bfe_u32 v7, v5, 1, 1
    v_and_or_b32 v7, v5, 4, v7
    v_and_b32 v0, 7, v1
    v_xor_b32 v7, v7, v0
    v_mul_u32_u24 v30, 6144, v5
    v_lshl_add_u32 v30, v7, 4, v30
    v_lshl_add_u32 v21, v2, 4, s92
    s_mov_b32 s50, 61440
    s_mov_b32 s51, 0x00020000
    s_mov_b32 s42, 61440
    s_mov_b32 s43, 0x00020000
    s_mov_b32 s46, 3932160
    s_mov_b32 s47, 0x00020000
    s_waitcnt lgkmcnt(0)
    s_mov_b32 s48, s8
    s_and_b32 s49, s9, 0xffff
    s_mov_b32 s40, s10
    s_and_b32 s41, s11, 0xffff
    s_add_u32 m0, s92, 12288
    v_lshlrev_b32 v0, 2, v1
    buffer_load_dword v0, s[48:51], s71 offen lds
    s_add_u32 m0, s92, 12544
    s_nop 0
    buffer_load_dword v0, s[40:43], s71 offen lds
    s_mov_b32 s44, s6
    s_and_b32 s45, s7, 0xffff
    s_add_u32 m0, s92, 16384
    s_add_u32 s72, s70, 0
    buffer_load_dwordx4 v30, s[44:47], s72 offen lds
    s_add_u32 m0, s92, 17408
    s_add_u32 s72, s70, 49152
    buffer_load_dwordx4 v30, s[44:47], s72 offen lds
    s_add_u32 m0, s92, 18432
    s_add_u32 s72, s70, 128
    buffer_load_dwordx4 v30, s[44:47], s72 offen lds
    s_add_u32 m0, s92, 19456
    s_add_u32 s72, s70, 49280
    buffer_load_dwordx4 v30, s[44:47], s72 offen lds
    s_add_u32 m0, s92, 20480
    s_add_u32 s72, s70, 256
    buffer_load_dwordx4 v30, s[44:47], s72 offen lds
    s_add_u32 m0, s92, 21504
    s_add_u32 s72, s70, 49408
    buffer_load_dwordx4 v30, s[44:47], s72 offen lds
    s_add_u32 m0, s92, 22528
    s_add_u32 s72, s70, 98304
    buffer_load_dwordx4 v30, s[44:47], s72 offen lds
    s_add_u32 m0, s92, 23552
    s_add_u32 s72, s70, 147456
    buffer_load_dwordx4 v30, s[44:47], s72 offen lds
    s_add_u32 m0, s92, 24576
    s_add_u32 s72, s70, 98432
    buffer_load_dwordx4 v30, s[44:47], s72 offen lds
    s_add_u32 m0, s92, 25600
    s_add_u32 s72, s70, 147584
    buffer_load_dwordx4 v30, s[44:47], s72 offen lds
    s_add_u32 m0, s92, 26624
    s_add_u32 s72, s70, 98560
    buffer_load_dwordx4 v30, s[44:47], s72 offen lds
    s_add_u32 m0, s92, 27648
    s_add_u32 s72, s70, 147712
    buffer_load_dwordx4 v30, s[44:47], s72 offen lds
    s_barrier
    v_mul_u32_u24 v0, 3072, v5
    v_add_u32 v5, v0, v6
    v_xor_b32 v0, 64, v5
    v_add_u32 v6, 23552, v0
    v_add_u32 v7, 47104, v5
    v_add_u32 v8, 70656, v0
    s_mov_b32 s34, 4718592
    s_mov_b32 s35, 0x00020000
    s_lshr_b32 s64, 0x60606060, s89
    s_and_b32 s64, s64, 15
    s_mul_i32 s65, s3, 12
    s_add_u32 s64, s64, s65
    s_lshl_b32 s86, s64, 10
    s_mul_i32 s87, s64, 98304
    s_lshl_b32 s65, s60, 7
    s_add_u32 s87, s87, s65
    s_mov_b32 s32, s14
    s_and_b32 s33, s15, 0xffff
    s_mov_b32 s36, s20
    s_and_b32 s37, s21, 0xffff
    v_lshrrev_b32 v0, 3, v3
    v_and_b32 v9, 1, v2
    v_lshl_or_b32 v0, v9, 1, v0
    v_lshrrev_b32 v9, 2, v3
    v_lshl_add_u32 v0, v9, 2, v0
    v_lshl_add_u32 v0, v2, 5, v0
    v_lshlrev_b32 v9, 5, v0
    v_and_b32 v0, 3, v3
    v_lshl_add_u32 v0, v0, 3, v9
    s_lshl_b32 s64, s3, 5
    v_xor_b32 v0, s64, v0
    v_add_u32 v9, s92, v0
    v_xor_b32 v10, 32, v9
    v_xor_b32 v11, 64, v9
    v_xor_b32 v12, 96, v9
    v_add_u32 v26, 196608, v4
    v_bfe_u32 v0, v3, 1, 1
    v_and_or_b32 v0, v3, 4, v0
    v_lshlrev_b32 v31, 1, v2
    v_xor_b32 v0, v0, v31
    v_lshl_add_u32 v0, v3, 3, v0
    v_lshl_add_u32 v30, v0, 4, s92
    v_xor_b32 v31, 16, v30
    s_mov_b32 s40, s16
    s_and_b32 s41, s17, 0xffff
    s_mov_b32 s42, 6291456
    s_mov_b32 s43, 0x00020000
    s_and_b32 s64, s56, 3
    s_lshl_b32 s6, s22, 2
    s_add_u32 s6, s6, s64
    s_lshr_b32 s65, s56, 2
    s_lshl_b32 s7, s23, 3
    s_add_u32 s7, s7, s65
    s_lshr_b32 s14, s3, 1
    s_lshl1_add_u32 s14, s6, s14
    s_lshl_b32 s14, s14, 10
    s_add_u32 s14, s14, 178298880
    s_mov_b32 s13, 178331648
    s_mul_i32 s68, s64, 1
    s_add_u32 s68, s68, s65
    s_mov_b32 s54, 0x46814688
    s_bitcmp1_b32 s68, 2
    s_cselect_b32 s54, 0x46814688, s54
    s_lshl_b32 s69, s68, 4
    s_and_b32 s69, s69, 16
    s_lshr_b32 s12, s54, s69
    s_bitcmp1_b32 s68, 1
    s_cselect_b32 s16, 10240, 0
    s_sub_u32 s17, 10240, s16
    v_and_b32 v17, 7, v3
    v_lshlrev_b32 v17, 7, v17
    s_and_b32 s65, s3, 1
    s_lshl1_add_u32 s64, s7, s65
    s_mul_i32 s64, s64, 12
    v_add_u32 v19, s64, v3
    s_lshl2_add_u32 s65, s60, s3
    s_lshl_b32 s65, s65, 2
    s_sub_u32 s65, s65, 12
    s_mov_b32 exec_lo, 0xf000f000
    s_mov_b32 exec_hi, 0xf000f000
    v_add_u32 v19, s65, v3
    s_mov_b64 exec, -1
    v_lshlrev_b32 v19, 7, v19
    v_lshlrev_b32 v25, 2, v3
    s_mul_i32 s64, s61, 98304
    s_mul_i32 s65, s62, 3072
    s_add_u32 s8, s64, s65
    s_add_u32 s8, s8, 176160768
    s_lshl4_add_u32 s64, s61, s62
    s_lshl_b32 s5, s64, 7
    s_add_u32 s5, s5, 178257920
    s_cmp_ge_u32 s56, 20
    s_cselect_b32 s8, 0x20000000, s8
    s_cselect_b32 s5, 0x20000000, s5
    s_add_u32 s10, s8, 49152
    s_mov_b32 s4, 0x20000000
    s_mul_i32 s64, s58, 20
    s_add_u32 s88, s59, s64
    s_lshl2_add_u32 s64, s60, s3
    s_mul_i32 s64, s64, 20480
    s_lshl_b32 s79, s88, 9
    s_add_u32 s79, s79, s64
    s_add_u32 s79, s79, 170917888
    s_add_u32 s80, s79, 4096
    s_add_u32 s81, s79, 8192
    s_lshr_b32 s85, 0x20202020, s89
    s_lshl2_add_u32 s85, s3, s85
    s_lshr_b32 s65, s88, 1
    s_lshl_b32 s65, s65, 11
    s_mov_b32 s9, 178257920
    v_lshrrev_b32 v0, 2, v1
    v_min_u32 v0, 4, v0
    v_and_b32 v1, 3, v3
    v_add_u32 v1, s85, v1
    v_and_b32 v1, 15, v1
    v_lshl_add_u32 v0, v0, 5, v1
    v_lshl_add_u32 v1, v0, 7, s65
    s_sub_u32 s64, s13, s9
    s_mov_b32 exec_lo, 0
    v_add_u32 v1, s64, v19
    s_mov_b64 exec, -1
    s_mul_i32 s88, s88, 49152
    s_add_u32 s88, s88, 176160768
    v_add_u32 v27, 393216, v4
    v_lshrrev_b32 v0, 1, v2
    v_lshl_add_u32 v0, v0, 4, v3
    v_and_b32 v28, 1, v2
    v_lshl_add_u32 v28, v0, 1, v28
    v_lshlrev_b32 v28, 3, v28
    s_xor_b32 s64, s3, 0
    s_mul_i32 s64, s64, 3072
    s_add_u32 s64, s64, 110592
    v_add_u32 v13, s64, v4
    s_xor_b32 s64, s3, 1
    s_mul_i32 s64, s64, 3072
    s_add_u32 s64, s64, 110592
    v_add_u32 v14, s64, v4
    s_xor_b32 s64, s3, 2
    s_mul_i32 s64, s64, 3072
    s_add_u32 s64, s64, 111616
    v_add_u32 v15, s64, v4
    s_xor_b32 s64, s3, 3
    s_mul_i32 s64, s64, 3072
    s_add_u32 s64, s64, 112640
    v_add_u32 v16, s64, v4
    s_lshl_b32 s54, s6, 3
    s_lshl_b32 s55, s3, 1
    s_add_u32 s54, s54, s55
    s_mul_i32 s55, s54, 20480
    s_add_u32 s55, s55, 167772160
    v_add_u32 v148, s55, v4
    v_add_u32 v149, 20480, v148
    s_lshl_b32 s54, s54, 4
    v_add_u32 v150, s54, v3
    v_mul_u32_u24 v150, 3072, v150
    v_and_b32 v151, 1, v2
    v_lshl_add_u32 v150, v151, 5, v150
    v_lshlrev_b32 v155, 9, v151
    v_lshrrev_b32 v151, 1, v2
    v_lshl_add_u32 v150, v151, 4, v150
    v_lshl_add_u32 v155, v151, 8, v155
    v_lshl_add_u32 v155, v3, 4, v155
    s_mul_i32 s54, s7, 192
    v_add_u32 v150, s54, v150
    v_add_u32 v151, 49152, v150
    s_and_b32 s54, s3, 1
    s_mul_i32 s54, s54, 3
    s_mul_i32 s55, s7, 6
    s_add_u32 s54, s54, s55
    s_mul_i32 s54, s54, 20480
    s_lshr_b32 s55, s3, 1
    s_lshl_b32 s55, s55, 10
    s_add_u32 s54, s54, s55
    s_add_u32 s54, s54, 170917888
    v_add_u32 v152, s54, v4
    v_add_u32 v153, 19456, v152
    v_add_u32 v154, 38912, v152
    v_add_u32 v156, 61440, v155
    s_mul_i32 s22, s3, 3072
    v_add_u32 v157, s22, v4
    v_add_u32 v158, 61440, v157
    s_bfe_u32 s55, s12, 0x30000
    s_lshl_b32 s55, s55, 11
    s_add_u32 s57, s55, s16
    s_add_u32 s58, s55, s17
    s_bfe_u32 s55, s12, 0x30003
    s_lshl_b32 s55, s55, 11
    s_add_u32 s59, s55, s16
    s_add_u32 s60, s55, s17
    s_bfe_u32 s55, s12, 0x30006
    s_lshl_b32 s55, s55, 11
    s_add_u32 s61, s55, s16
    s_add_u32 s62, s55, s17
    s_bfe_u32 s55, s12, 0x30009
    s_lshl_b32 s55, s55, 11
    s_add_u32 s63, s55, s16
    s_add_u32 s64, s55, s17
    s_bfe_u32 s55, s12, 0x3000c
    s_lshl_b32 s55, s55, 11
    s_add_u32 s65, s55, s16
    s_add_u32 s66, s55, s17
    s_add_u32 s44, s86, s88
    s_add_u32 s86, s86, 1024
    s_add_u32 s45, s86, s88
    s_add_u32 s86, s86, 1024
    s_add_u32 s46, s86, s88
    s_add_u32 s86, s86, 1024
    s_cmp_ge_u32 s86, 49152
    s_cselect_b32 s86, 0, s86
    s_add_u32 s47, s86, s88
    s_add_u32 s86, s86, 1024
    s_add_u32 s48, s86, s88
    s_add_u32 s86, s86, 1024
    s_add_u32 s49, s86, s88
    s_add_u32 s86, s86, 1024
    s_cmp_ge_u32 s86, 49152
    s_cselect_b32 s86, 0, s86
    s_add_u32 s50, s86, s88
    s_add_u32 s86, s86, 1024
    s_add_u32 s51, s86, s88
    s_add_u32 s86, s86, 1024
    s_add_u32 s74, s86, s88
    s_add_u32 s86, s86, 1024
    s_cmp_ge_u32 s86, 49152
    s_cselect_b32 s86, 0, s86
    s_add_u32 s75, s86, s88
    s_add_u32 s86, s86, 1024
    s_add_u32 s76, s86, s88
    s_add_u32 s86, s86, 1024
    s_add_u32 s77, s86, s88
    s_waitcnt vmcnt(12)
    ds_read_b128 v[176:179], v21 offset:12288
    ds_read_b128 v[180:183], v21 offset:12544
    ds_read_b128 v[184:187], v21 offset:12352
    ds_read_b128 v[188:191], v21 offset:12608
    ds_read_b128 v[192:195], v21 offset:12416
    ds_read_b128 v[196:199], v21 offset:12672
    s_waitcnt lgkmcnt(4)
    v_lshlrev_b32 v224, 16, v180
    v_and_b32 v225, 0xffff0000, v180
    v_lshlrev_b32 v200, 16, v176
    v_and_b32 v201, 0xffff0000, v176
    v_lshlrev_b32 v226, 16, v181
    v_and_b32 v227, 0xffff0000, v181
    v_lshlrev_b32 v202, 16, v177
    v_and_b32 v203, 0xffff0000, v177
    v_lshlrev_b32 v228, 16, v182
    v_and_b32 v229, 0xffff0000, v182
    v_lshlrev_b32 v204, 16, v178
    v_and_b32 v205, 0xffff0000, v178
    v_lshlrev_b32 v230, 16, v183
    v_and_b32 v231, 0xffff0000, v183
    v_lshlrev_b32 v206, 16, v179
    v_and_b32 v207, 0xffff0000, v179
    v_pk_mul_f32 v[224:225], v[224:225], v[200:201] neg_lo:[1,0] neg_hi:[1,0]
    v_pk_mul_f32 v[226:227], v[226:227], v[202:203] neg_lo:[1,0] neg_hi:[1,0]
    v_pk_mul_f32 v[228:229], v[228:229], v[204:205] neg_lo:[1,0] neg_hi:[1,0]
    v_pk_mul_f32 v[230:231], v[230:231], v[206:207] neg_lo:[1,0] neg_hi:[1,0]
    s_waitcnt lgkmcnt(2)
    v_lshlrev_b32 v232, 16, v188
    v_and_b32 v233, 0xffff0000, v188
    v_lshlrev_b32 v208, 16, v184
    v_and_b32 v209, 0xffff0000, v184
    v_lshlrev_b32 v234, 16, v189
    v_and_b32 v235, 0xffff0000, v189
    v_lshlrev_b32 v210, 16, v185
    v_and_b32 v211, 0xffff0000, v185
    v_lshlrev_b32 v236, 16, v190
    v_and_b32 v237, 0xffff0000, v190
    v_lshlrev_b32 v212, 16, v186
    v_and_b32 v213, 0xffff0000, v186
    v_lshlrev_b32 v238, 16, v191
    v_and_b32 v239, 0xffff0000, v191
    v_lshlrev_b32 v214, 16, v187
    v_and_b32 v215, 0xffff0000, v187
    v_pk_mul_f32 v[232:233], v[232:233], v[208:209] neg_lo:[1,0] neg_hi:[1,0]
    v_pk_mul_f32 v[234:235], v[234:235], v[210:211] neg_lo:[1,0] neg_hi:[1,0]
    v_pk_mul_f32 v[236:237], v[236:237], v[212:213] neg_lo:[1,0] neg_hi:[1,0]
    v_pk_mul_f32 v[238:239], v[238:239], v[214:215] neg_lo:[1,0] neg_hi:[1,0]
    s_waitcnt lgkmcnt(0)
    v_lshlrev_b32 v240, 16, v196
    v_and_b32 v241, 0xffff0000, v196
    v_lshlrev_b32 v216, 16, v192
    v_and_b32 v217, 0xffff0000, v192
    v_lshlrev_b32 v242, 16, v197
    v_and_b32 v243, 0xffff0000, v197
    v_lshlrev_b32 v218, 16, v193
    v_and_b32 v219, 0xffff0000, v193
    v_lshlrev_b32 v244, 16, v198
    v_and_b32 v245, 0xffff0000, v198
    v_lshlrev_b32 v220, 16, v194
    v_and_b32 v221, 0xffff0000, v194
    v_lshlrev_b32 v246, 16, v199
    v_and_b32 v247, 0xffff0000, v199
    v_lshlrev_b32 v222, 16, v195
    v_and_b32 v223, 0xffff0000, v195
    v_pk_mul_f32 v[240:241], v[240:241], v[216:217] neg_lo:[1,0] neg_hi:[1,0]
    v_pk_mul_f32 v[242:243], v[242:243], v[218:219] neg_lo:[1,0] neg_hi:[1,0]
    v_pk_mul_f32 v[244:245], v[244:245], v[220:221] neg_lo:[1,0] neg_hi:[1,0]
    v_pk_mul_f32 v[246:247], v[246:247], v[222:223] neg_lo:[1,0] neg_hi:[1,0]
    s_waitcnt vmcnt(10)
    ds_read_b128 v[32:35], v30 offset:16384
    ds_read_b128 v[36:39], v31 offset:16384
    s_waitcnt vmcnt(8)
    ds_read_b128 v[40:43], v30 offset:18432
    ds_read_b128 v[44:47], v31 offset:18432
    s_waitcnt lgkmcnt(2)
    v_cvt_f32_i32 v32, v32
    v_cvt_f32_i32 v33, v33
    v_cvt_f32_i32 v34, v34
    v_cvt_f32_i32 v35, v35
    v_cvt_f32_i32 v36, v36
    v_cvt_f32_i32 v37, v37
    v_cvt_f32_i32 v38, v38
    v_cvt_f32_i32 v39, v39
    v_pk_fma_f32 v[32:33], v[32:33], v[200:201], v[224:225]
    v_pk_fma_f32 v[34:35], v[34:35], v[202:203], v[226:227]
    v_pk_fma_f32 v[36:37], v[36:37], v[204:205], v[228:229]
    v_pk_fma_f32 v[38:39], v[38:39], v[206:207], v[230:231]
    v_cvt_pk_bf16_f32 v120, v32, v33
    v_cvt_pk_bf16_f32 v121, v34, v35
    v_cvt_pk_bf16_f32 v122, v36, v37
    v_cvt_pk_bf16_f32 v123, v38, v39
    buffer_store_dwordx4 v[120:123], v4, s[36:39], s8 offen offset:0 sc1
    s_waitcnt vmcnt(7)
    ds_read_b128 v[48:51], v30 offset:20480
    ds_read_b128 v[52:55], v31 offset:20480
    s_waitcnt lgkmcnt(2)
    v_cvt_f32_i32 v40, v40
    v_cvt_f32_i32 v41, v41
    v_cvt_f32_i32 v42, v42
    v_cvt_f32_i32 v43, v43
    v_cvt_f32_i32 v44, v44
    v_cvt_f32_i32 v45, v45
    v_cvt_f32_i32 v46, v46
    v_cvt_f32_i32 v47, v47
    v_pk_fma_f32 v[40:41], v[40:41], v[208:209], v[232:233]
    v_pk_fma_f32 v[42:43], v[42:43], v[210:211], v[234:235]
    v_pk_fma_f32 v[44:45], v[44:45], v[212:213], v[236:237]
    v_pk_fma_f32 v[46:47], v[46:47], v[214:215], v[238:239]
    v_cvt_pk_bf16_f32 v124, v40, v41
    v_cvt_pk_bf16_f32 v125, v42, v43
    v_cvt_pk_bf16_f32 v126, v44, v45
    v_cvt_pk_bf16_f32 v127, v46, v47
    buffer_store_dwordx4 v[124:127], v4, s[36:39], s8 offen offset:1024 sc1
    s_waitcnt vmcnt(6)
    ds_read_b128 v[56:59], v30 offset:22528
    ds_read_b128 v[60:63], v31 offset:22528
    global_load_dword v24, v25, s[18:19]
    s_waitcnt lgkmcnt(2)
    v_cvt_f32_i32 v48, v48
    v_cvt_f32_i32 v49, v49
    v_cvt_f32_i32 v50, v50
    v_cvt_f32_i32 v51, v51
    v_cvt_f32_i32 v52, v52
    v_cvt_f32_i32 v53, v53
    v_cvt_f32_i32 v54, v54
    v_cvt_f32_i32 v55, v55
    v_pk_fma_f32 v[48:49], v[48:49], v[216:217], v[240:241]
    v_pk_fma_f32 v[50:51], v[50:51], v[218:219], v[242:243]
    v_pk_fma_f32 v[52:53], v[52:53], v[220:221], v[244:245]
    v_pk_fma_f32 v[54:55], v[54:55], v[222:223], v[246:247]
    v_cvt_pk_bf16_f32 v128, v48, v49
    v_cvt_pk_bf16_f32 v129, v50, v51
    v_cvt_pk_bf16_f32 v130, v52, v53
    v_cvt_pk_bf16_f32 v131, v54, v55
    buffer_store_dwordx4 v[128:131], v4, s[36:39], s8 offen offset:2048 sc1
    s_waitcnt vmcnt(6)
    ds_read_b128 v[64:67], v30 offset:24576
    ds_read_b128 v[68:71], v31 offset:24576
    s_waitcnt lgkmcnt(2)
    v_cvt_f32_i32 v56, v56
    v_cvt_f32_i32 v57, v57
    v_cvt_f32_i32 v58, v58
    v_cvt_f32_i32 v59, v59
    v_cvt_f32_i32 v60, v60
    v_cvt_f32_i32 v61, v61
    v_cvt_f32_i32 v62, v62
    v_cvt_f32_i32 v63, v63
    v_pk_fma_f32 v[56:57], v[56:57], v[200:201], v[224:225]
    v_pk_fma_f32 v[58:59], v[58:59], v[202:203], v[226:227]
    v_pk_fma_f32 v[60:61], v[60:61], v[204:205], v[228:229]
    v_pk_fma_f32 v[62:63], v[62:63], v[206:207], v[230:231]
    v_cvt_pk_bf16_f32 v132, v56, v57
    v_cvt_pk_bf16_f32 v133, v58, v59
    v_cvt_pk_bf16_f32 v134, v60, v61
    v_cvt_pk_bf16_f32 v135, v62, v63
    buffer_store_dwordx4 v[132:135], v4, s[36:39], s10 offen offset:0 sc1
    s_waitcnt vmcnt(5)
    ds_read_b128 v[72:75], v30 offset:26624
    ds_read_b128 v[76:79], v31 offset:26624
    s_waitcnt lgkmcnt(2)
    v_cvt_f32_i32 v64, v64
    v_cvt_f32_i32 v65, v65
    v_cvt_f32_i32 v66, v66
    v_cvt_f32_i32 v67, v67
    v_cvt_f32_i32 v68, v68
    v_cvt_f32_i32 v69, v69
    v_cvt_f32_i32 v70, v70
    v_cvt_f32_i32 v71, v71
    v_pk_fma_f32 v[64:65], v[64:65], v[208:209], v[232:233]
    v_pk_fma_f32 v[66:67], v[66:67], v[210:211], v[234:235]
    v_pk_fma_f32 v[68:69], v[68:69], v[212:213], v[236:237]
    v_pk_fma_f32 v[70:71], v[70:71], v[214:215], v[238:239]
    v_cvt_pk_bf16_f32 v136, v64, v65
    v_cvt_pk_bf16_f32 v137, v66, v67
    v_cvt_pk_bf16_f32 v138, v68, v69
    v_cvt_pk_bf16_f32 v139, v70, v71
    buffer_store_dwordx4 v[136:139], v4, s[36:39], s10 offen offset:1024 sc1
    s_waitcnt lgkmcnt(0)
    v_cvt_f32_i32 v72, v72
    v_cvt_f32_i32 v73, v73
    v_cvt_f32_i32 v74, v74
    v_cvt_f32_i32 v75, v75
    v_cvt_f32_i32 v76, v76
    v_cvt_f32_i32 v77, v77
    v_cvt_f32_i32 v78, v78
    v_cvt_f32_i32 v79, v79
    v_pk_fma_f32 v[72:73], v[72:73], v[216:217], v[240:241]
    v_pk_fma_f32 v[74:75], v[74:75], v[218:219], v[242:243]
    v_pk_fma_f32 v[76:77], v[76:77], v[220:221], v[244:245]
    v_pk_fma_f32 v[78:79], v[78:79], v[222:223], v[246:247]
    v_cvt_pk_bf16_f32 v140, v72, v73
    v_cvt_pk_bf16_f32 v141, v74, v75
    v_cvt_pk_bf16_f32 v142, v76, v77
    v_cvt_pk_bf16_f32 v143, v78, v79
    buffer_store_dwordx4 v[140:143], v4, s[36:39], s10 offen offset:2048 sc1
    s_barrier
    v_add_u32 v30, 589824, v4
    v_add_u32 v31, 786432, v4
    s_add_u32 m0, s92, 0
    s_nop 0
    buffer_load_dwordx4 v5, s[32:35], s87 offen offset:0 lds
    buffer_load_dwordx4 v6, s[32:35], s87 offen offset:1024 lds
    buffer_load_dwordx4 v7, s[32:35], s87 offen offset:2048 lds
    buffer_load_dwordx4 v8, s[32:35], s87 offen offset:3072 lds
    s_add_u32 m0, s92, 4096
    s_add_u32 s87, s87, 98304
    s_cmp_ge_u32 s87, 4718592
    s_cselect_b32 s55, 4718592, 0
    s_sub_u32 s87, s87, s55
    buffer_load_dwordx4 v5, s[32:35], s87 offen offset:0 lds
    buffer_load_dwordx4 v6, s[32:35], s87 offen offset:1024 lds
    buffer_load_dwordx4 v7, s[32:35], s87 offen offset:2048 lds
    buffer_load_dwordx4 v8, s[32:35], s87 offen offset:3072 lds
    s_waitcnt vmcnt(8)
    v_cmp_ne_u32 vcc, 1, v24
    s_cmp_lg_u64 vcc, 0
    s_cbranch_scc1 L_r_sl1
L_r_bk1:
    s_mov_b64 exec, 1
    buffer_store_dword v20, v4, s[36:39], s5 offen sc1
    s_mov_b64 exec, -1
    s_barrier
    s_add_u32 m0, s92, 8192
    s_add_u32 s87, s87, 98304
    s_cmp_ge_u32 s87, 4718592
    s_cselect_b32 s55, 4718592, 0
    s_sub_u32 s87, s87, s55
    buffer_load_dwordx4 v5, s[32:35], s87 offen offset:0 lds
    buffer_load_dwordx4 v6, s[32:35], s87 offen offset:1024 lds
    buffer_load_dwordx4 v7, s[32:35], s87 offen offset:2048 lds
    buffer_load_dwordx4 v8, s[32:35], s87 offen offset:3072 lds
    s_add_u32 m0, s92, 12288
    s_add_u32 s87, s87, 98304
    s_cmp_ge_u32 s87, 4718592
    s_cselect_b32 s55, 4718592, 0
    s_sub_u32 s87, s87, s55
    buffer_load_dwordx4 v5, s[32:35], s87 offen offset:0 lds
    buffer_load_dwordx4 v6, s[32:35], s87 offen offset:1024 lds
    buffer_load_dwordx4 v7, s[32:35], s87 offen offset:2048 lds
    buffer_load_dwordx4 v8, s[32:35], s87 offen offset:3072 lds
    s_add_u32 m0, s92, 16384
    s_add_u32 s87, s87, 98304
    s_cmp_ge_u32 s87, 4718592
    s_cselect_b32 s55, 4718592, 0
    s_sub_u32 s87, s87, s55
    buffer_load_dwordx4 v5, s[32:35], s87 offen offset:0 lds
    buffer_load_dwordx4 v6, s[32:35], s87 offen offset:1024 lds
    buffer_load_dwordx4 v7, s[32:35], s87 offen offset:2048 lds
    buffer_load_dwordx4 v8, s[32:35], s87 offen offset:3072 lds
    s_add_u32 m0, s92, 20480
    s_add_u32 s87, s87, 98304
    s_cmp_ge_u32 s87, 4718592
    s_cselect_b32 s55, 4718592, 0
    s_sub_u32 s87, s87, s55
    buffer_load_dwordx4 v5, s[32:35], s87 offen offset:0 lds
    buffer_load_dwordx4 v6, s[32:35], s87 offen offset:1024 lds
    buffer_load_dwordx4 v7, s[32:35], s87 offen offset:2048 lds
    buffer_load_dwordx4 v8, s[32:35], s87 offen offset:3072 lds
    s_branch L_mrg
L_tch:
    s_and_b32 s64, s3, 1
    s_lshl1_add_u32 s72, s56, s64
    s_and_b32 s64, s2, 7
    s_mul_i32 s64, s64, 48
    s_add_u32 s73, s72, s64
    s_mul_i32 s70, s73, 5120
    s_add_u32 s70, s70, 170917888
    v_mov_b32 v100, -1
    v_mov_b32 v101, -1
    v_mov_b32 v102, -1
    v_mov_b32 v103, -1
    v_mul_u32_u24 v96, 13108, v1
    v_lshrrev_b32 v96, 16, v96
    v_mul_u32_u24 v96, 640, v96
    v_lshl_add_u32 v96, v1, 7, v96
    s_mul_i32 s71, s72, 14080
    s_mul_i32 s64, s22, 655360
    s_add_u32 s71, s71, s64
    s_mul_i32 s72, s72, 8960
    s_mul_i32 s64, s23, 640
    s_add_u32 s72, s72, s64
    v_mul_u32_u24 v0, 3072, v5
    v_add_u32 v5, v0, v6
    v_xor_b32 v0, 64, v5
    v_add_u32 v6, 23552, v0
    v_add_u32 v7, 47104, v5
    v_add_u32 v8, 70656, v0
    s_mov_b32 s34, 4718592
    s_mov_b32 s35, 0x00020000
    s_lshr_b32 s64, 0x60606060, s89
    s_and_b32 s64, s64, 15
    s_mul_i32 s65, s3, 12
    s_add_u32 s64, s64, s65
    s_lshl_b32 s86, s64, 10
    s_mul_i32 s87, s64, 98304
    s_lshl_b32 s65, s60, 7
    s_add_u32 s87, s87, s65
    s_waitcnt lgkmcnt(0)
    s_barrier
    s_mov_b32 s36, s20
    s_and_b32 s37, s21, 0xffff
    buffer_store_dwordx4 v[100:103], v4, s[36:39], s70 offen offset:0 sc1
    buffer_store_dwordx4 v[100:103], v4, s[36:39], s70 offen offset:1024 sc1
    buffer_store_dwordx4 v[100:103], v4, s[36:39], s70 offen offset:2048 sc1
    buffer_store_dwordx4 v[100:103], v4, s[36:39], s70 offen offset:3072 sc1
    s_add_u32 s70, s70, 4096
    buffer_store_dwordx4 v[100:103], v4, s[36:39], s70 offen offset:0 sc1
    s_mov_b32 s24, s4
    s_and_b32 s25, s5, 0xffff
    s_bfm_b64 exec, 55, 0
    buffer_load_dword v94, v96, s[24:27], s71 offen
    s_mov_b64 exec, -1
    s_mov_b32 s28, s12
    s_and_b32 s29, s13, 0xffff
    s_bfm_b64 exec, 35, 0
    buffer_load_dword v94, v96, s[28:31], s72 offen
    s_mov_b64 exec, -1
    s_mov_b32 s32, s14
    s_and_b32 s33, s15, 0xffff
    s_add_u32 m0, s92, 0
    s_nop 0
    buffer_load_dwordx4 v5, s[32:35], s87 offen offset:0 lds
    buffer_load_dwordx4 v6, s[32:35], s87 offen offset:1024 lds
    buffer_load_dwordx4 v7, s[32:35], s87 offen offset:2048 lds
    buffer_load_dwordx4 v8, s[32:35], s87 offen offset:3072 lds
    s_add_u32 m0, s92, 4096
    s_add_u32 s87, s87, 98304
    s_cmp_ge_u32 s87, 4718592
    s_cselect_b32 s55, 4718592, 0
    s_sub_u32 s87, s87, s55
    buffer_load_dwordx4 v5, s[32:35], s87 offen offset:0 lds
    buffer_load_dwordx4 v6, s[32:35], s87 offen offset:1024 lds
    buffer_load_dwordx4 v7, s[32:35], s87 offen offset:2048 lds
    buffer_load_dwordx4 v8, s[32:35], s87 offen offset:3072 lds
    v_lshrrev_b32 v0, 3, v3
    v_and_b32 v9, 1, v2
    v_lshl_or_b32 v0, v9, 1, v0
    v_lshrrev_b32 v9, 2, v3
    v_lshl_add_u32 v0, v9, 2, v0
    v_lshl_add_u32 v0, v2, 5, v0
    v_lshlrev_b32 v9, 5, v0
    v_and_b32 v0, 3, v3
    v_lshl_add_u32 v0, v0, 3, v9
    s_lshl_b32 s64, s3, 5
    v_xor_b32 v0, s64, v0
    v_add_u32 v9, s92, v0
    v_xor_b32 v10, 32, v9
    v_xor_b32 v11, 64, v9
    v_xor_b32 v12, 96, v9
    v_add_u32 v26, 196608, v4
    s_mov_b32 s40, s16
    s_and_b32 s41, s17, 0xffff
    s_mov_b32 s42, 6291456
    s_mov_b32 s43, 0x00020000
    s_and_b32 s64, s56, 3
    s_lshl_b32 s6, s22, 2
    s_add_u32 s6, s6, s64
    s_lshr_b32 s65, s56, 2
    s_lshl_b32 s7, s23, 3
    s_add_u32 s7, s7, s65
    s_lshr_b32 s14, s3, 1
    s_lshl1_add_u32 s14, s6, s14
    s_lshl_b32 s14, s14, 10
    s_add_u32 s14, s14, 178298880
    s_mov_b32 s13, 178331648
    s_mul_i32 s68, s64, 1
    s_add_u32 s68, s68, s65
    s_mov_b32 s54, 0x46814688
    s_bitcmp1_b32 s68, 2
    s_cselect_b32 s54, 0x46814688, s54
    s_lshl_b32 s69, s68, 4
    s_and_b32 s69, s69, 16
    s_lshr_b32 s12, s54, s69
    s_bitcmp1_b32 s68, 1
    s_cselect_b32 s16, 10240, 0
    s_sub_u32 s17, 10240, s16
    v_and_b32 v17, 7, v3
    v_lshlrev_b32 v17, 7, v17
    s_and_b32 s65, s3, 1
    s_lshl1_add_u32 s64, s7, s65
    s_mul_i32 s64, s64, 12
    v_add_u32 v19, s64, v3
    s_lshl2_add_u32 s65, s60, s3
    s_lshl_b32 s65, s65, 2
    s_sub_u32 s65, s65, 12
    s_mov_b32 exec_lo, 0xf000f000
    s_mov_b32 exec_hi, 0xf000f000
    v_add_u32 v19, s65, v3
    s_mov_b64 exec, -1
    v_lshlrev_b32 v19, 7, v19
    v_lshlrev_b32 v25, 2, v3
    s_lshl_b32 s4, s73, 7
    s_add_u32 s4, s4, 178331648
    s_mul_i32 s64, s58, 20
    s_add_u32 s88, s59, s64
    s_lshl2_add_u32 s64, s60, s3
    s_mul_i32 s64, s64, 20480
    s_lshl_b32 s79, s88, 9
    s_add_u32 s79, s79, s64
    s_add_u32 s79, s79, 170917888
    s_add_u32 s80, s79, 4096
    s_add_u32 s81, s79, 8192
    s_lshr_b32 s85, 0x20202020, s89
    s_lshl2_add_u32 s85, s3, s85
    s_lshr_b32 s65, s88, 1
    s_lshl_b32 s65, s65, 11
    s_mov_b32 s9, 178257920
    v_lshrrev_b32 v0, 2, v1
    v_min_u32 v0, 4, v0
    v_and_b32 v1, 3, v3
    v_add_u32 v1, s85, v1
    v_and_b32 v1, 15, v1
    v_lshl_add_u32 v0, v0, 5, v1
    v_lshl_add_u32 v1, v0, 7, s65
    s_sub_u32 s64, s13, s9
    s_mov_b32 exec_lo, 0
    v_add_u32 v1, s64, v19
    s_mov_b64 exec, -1
    s_mul_i32 s88, s88, 49152
    s_add_u32 s88, s88, 176160768
    v_add_u32 v27, 393216, v4
    v_lshrrev_b32 v0, 1, v2
    v_lshl_add_u32 v0, v0, 4, v3
    v_and_b32 v28, 1, v2
    v_lshl_add_u32 v28, v0, 1, v28
    v_lshlrev_b32 v28, 3, v28
    s_xor_b32 s64, s3, 0
    s_mul_i32 s64, s64, 3072
    s_add_u32 s64, s64, 110592
    v_add_u32 v13, s64, v4
    s_xor_b32 s64, s3, 1
    s_mul_i32 s64, s64, 3072
    s_add_u32 s64, s64, 110592
    v_add_u32 v14, s64, v4
    s_xor_b32 s64, s3, 2
    s_mul_i32 s64, s64, 3072
    s_add_u32 s64, s64, 111616
    v_add_u32 v15, s64, v4
    s_xor_b32 s64, s3, 3
    s_mul_i32 s64, s64, 3072
    s_add_u32 s64, s64, 112640
    v_add_u32 v16, s64, v4
    s_lshl_b32 s54, s6, 3
    s_lshl_b32 s55, s3, 1
    s_add_u32 s54, s54, s55
    s_mul_i32 s55, s54, 20480
    s_add_u32 s55, s55, 167772160
    v_add_u32 v148, s55, v4
    v_add_u32 v149, 20480, v148
    s_lshl_b32 s54, s54, 4
    v_add_u32 v150, s54, v3
    v_mul_u32_u24 v150, 3072, v150
    v_and_b32 v151, 1, v2
    v_lshl_add_u32 v150, v151, 5, v150
    v_lshlrev_b32 v155, 9, v151
    v_lshrrev_b32 v151, 1, v2
    v_lshl_add_u32 v150, v151, 4, v150
    v_lshl_add_u32 v155, v151, 8, v155
    v_lshl_add_u32 v155, v3, 4, v155
    s_mul_i32 s54, s7, 192
    v_add_u32 v150, s54, v150
    v_add_u32 v151, 49152, v150
    s_and_b32 s54, s3, 1
    s_mul_i32 s54, s54, 3
    s_mul_i32 s55, s7, 6
    s_add_u32 s54, s54, s55
    s_mul_i32 s54, s54, 20480
    s_lshr_b32 s55, s3, 1
    s_lshl_b32 s55, s55, 10
    s_add_u32 s54, s54, s55
    s_add_u32 s54, s54, 170917888
    v_add_u32 v152, s54, v4
    v_add_u32 v153, 19456, v152
    v_add_u32 v154, 38912, v152
    v_add_u32 v156, 61440, v155
    s_mul_i32 s22, s3, 3072
    v_add_u32 v157, s22, v4
    v_add_u32 v158, 61440, v157
    s_bfe_u32 s55, s12, 0x30000
    s_lshl_b32 s55, s55, 11
    s_add_u32 s57, s55, s16
    s_add_u32 s58, s55, s17
    s_bfe_u32 s55, s12, 0x30003
    s_lshl_b32 s55, s55, 11
    s_add_u32 s59, s55, s16
    s_add_u32 s60, s55, s17
    s_bfe_u32 s55, s12, 0x30006
    s_lshl_b32 s55, s55, 11
    s_add_u32 s61, s55, s16
    s_add_u32 s62, s55, s17
    s_bfe_u32 s55, s12, 0x30009
    s_lshl_b32 s55, s55, 11
    s_add_u32 s63, s55, s16
    s_add_u32 s64, s55, s17
    s_bfe_u32 s55, s12, 0x3000c
    s_lshl_b32 s55, s55, 11
    s_add_u32 s65, s55, s16
    s_add_u32 s66, s55, s17
    s_add_u32 s44, s86, s88
    s_add_u32 s86, s86, 1024
    s_add_u32 s45, s86, s88
    s_add_u32 s86, s86, 1024
    s_add_u32 s46, s86, s88
    s_add_u32 s86, s86, 1024
    s_cmp_ge_u32 s86, 49152
    s_cselect_b32 s86, 0, s86
    s_add_u32 s47, s86, s88
    s_add_u32 s86, s86, 1024
    s_add_u32 s48, s86, s88
    s_add_u32 s86, s86, 1024
    s_add_u32 s49, s86, s88
    s_add_u32 s86, s86, 1024
    s_cmp_ge_u32 s86, 49152
    s_cselect_b32 s86, 0, s86
    s_add_u32 s50, s86, s88
    s_add_u32 s86, s86, 1024
    s_add_u32 s51, s86, s88
    s_add_u32 s86, s86, 1024
    s_add_u32 s74, s86, s88
    s_add_u32 s86, s86, 1024
    s_cmp_ge_u32 s86, 49152
    s_cselect_b32 s86, 0, s86
    s_add_u32 s75, s86, s88
    s_add_u32 s86, s86, 1024
    s_add_u32 s76, s86, s88
    s_add_u32 s86, s86, 1024
    s_add_u32 s77, s86, s88
    v_add_u32 v30, 589824, v4
    v_add_u32 v31, 786432, v4
    s_barrier
    s_bfm_b64 exec, 55, 0
    buffer_load_dword v94, v96, s[24:27], s71 offen offset:640
    s_mov_b64 exec, -1
    s_add_u32 s72, s72, 409600
    s_bfm_b64 exec, 35, 0
    buffer_load_dword v94, v96, s[28:31], s72 offen
    s_mov_b64 exec, -1
    s_add_u32 m0, s92, 8192
    s_add_u32 s87, s87, 98304
    s_cmp_ge_u32 s87, 4718592
    s_cselect_b32 s55, 4718592, 0
    s_sub_u32 s87, s87, s55
    buffer_load_dwordx4 v5, s[32:35], s87 offen offset:0 lds
    buffer_load_dwordx4 v6, s[32:35], s87 offen offset:1024 lds
    buffer_load_dwordx4 v7, s[32:35], s87 offen offset:2048 lds
    buffer_load_dwordx4 v8, s[32:35], s87 offen offset:3072 lds
    s_add_u32 m0, s92, 12288
    s_add_u32 s87, s87, 98304
    s_cmp_ge_u32 s87, 4718592
    s_cselect_b32 s55, 4718592, 0
    s_sub_u32 s87, s87, s55
    buffer_load_dwordx4 v5, s[32:35], s87 offen offset:0 lds
    buffer_load_dwordx4 v6, s[32:35], s87 offen offset:1024 lds
    buffer_load_dwordx4 v7, s[32:35], s87 offen offset:2048 lds
    buffer_load_dwordx4 v8, s[32:35], s87 offen offset:3072 lds
    s_add_u32 m0, s92, 16384
    s_add_u32 s87, s87, 98304
    s_cmp_ge_u32 s87, 4718592
    s_cselect_b32 s55, 4718592, 0
    s_sub_u32 s87, s87, s55
    buffer_load_dwordx4 v5, s[32:35], s87 offen offset:0 lds
    buffer_load_dwordx4 v6, s[32:35], s87 offen offset:1024 lds
    buffer_load_dwordx4 v7, s[32:35], s87 offen offset:2048 lds
    buffer_load_dwordx4 v8, s[32:35], s87 offen offset:3072 lds
    s_add_u32 m0, s92, 20480
    s_add_u32 s87, s87, 98304
    s_cmp_ge_u32 s87, 4718592
    s_cselect_b32 s55, 4718592, 0
    s_sub_u32 s87, s87, s55
    buffer_load_dwordx4 v5, s[32:35], s87 offen offset:0 lds
    buffer_load_dwordx4 v6, s[32:35], s87 offen offset:1024 lds
    buffer_load_dwordx4 v7, s[32:35], s87 offen offset:2048 lds
    buffer_load_dwordx4 v8, s[32:35], s87 offen offset:3072 lds
    s_waitcnt vmcnt(28)
    s_barrier
L_mrg:
    s_waitcnt vmcnt(21)
    ds_read_b64_tr_b16 a[0:1], v9 offset:0
    ds_read_b64_tr_b16 a[2:3], v11 offset:512
    ds_read_b64_tr_b16 a[4:5], v10 offset:0
    ds_read_b64_tr_b16 a[6:7], v12 offset:512
    ds_read_b64_tr_b16 a[8:9], v11 offset:0
    ds_read_b64_tr_b16 a[10:11], v9 offset:512
    ds_read_b64_tr_b16 a[12:13], v12 offset:0
    ds_read_b64_tr_b16 a[14:15], v10 offset:512
    s_waitcnt vmcnt(17)
    s_waitcnt lgkmcnt(7)
    ds_read_b64_tr_b16 a[16:17], v9 offset:4096
    ds_read_b64_tr_b16 a[18:19], v11 offset:4608
    ds_read_b64_tr_b16 a[20:21], v10 offset:4096
    ds_read_b64_tr_b16 a[22:23], v12 offset:4608
    ds_read_b64_tr_b16 a[24:25], v11 offset:4096
    ds_read_b64_tr_b16 a[26:27], v9 offset:4608
    ds_read_b64_tr_b16 a[28:29], v12 offset:4096
    ds_read_b64_tr_b16 a[30:31], v10 offset:4608
    s_waitcnt vmcnt(12)
    s_waitcnt lgkmcnt(7)
    ds_read_b64_tr_b16 a[32:33], v9 offset:8192
    ds_read_b64_tr_b16 a[34:35], v11 offset:8704
    ds_read_b64_tr_b16 a[36:37], v10 offset:8192
    ds_read_b64_tr_b16 a[38:39], v12 offset:8704
    ds_read_b64_tr_b16 a[40:41], v11 offset:8192
    ds_read_b64_tr_b16 a[42:43], v9 offset:8704
    ds_read_b64_tr_b16 a[44:45], v12 offset:8192
    ds_read_b64_tr_b16 a[46:47], v10 offset:8704
    s_add_u32 m0, s92, 24576
    s_add_u32 s87, s87, 98304
    s_cmp_ge_u32 s87, 4718592
    s_cselect_b32 s55, 4718592, 0
    s_sub_u32 s87, s87, s55
    buffer_load_dwordx4 v5, s[32:35], s87 offen offset:0 lds
    buffer_load_dwordx4 v6, s[32:35], s87 offen offset:1024 lds
    buffer_load_dwordx4 v7, s[32:35], s87 offen offset:2048 lds
    buffer_load_dwordx4 v8, s[32:35], s87 offen offset:3072 lds
    s_waitcnt vmcnt(12)
    s_waitcnt lgkmcnt(7)
    ds_read_b64_tr_b16 a[48:49], v9 offset:12288
    ds_read_b64_tr_b16 a[50:51], v11 offset:12800
    ds_read_b64_tr_b16 a[52:53], v10 offset:12288
    ds_read_b64_tr_b16 a[54:55], v12 offset:12800
    ds_read_b64_tr_b16 a[56:57], v11 offset:12288
    ds_read_b64_tr_b16 a[58:59], v9 offset:12800
    ds_read_b64_tr_b16 a[60:61], v12 offset:12288
    ds_read_b64_tr_b16 a[62:63], v10 offset:12800
    s_mov_b64 exec, 1
    buffer_store_dword v20, v4, s[36:39], s4 offen sc1
    s_mov_b64 exec, -1
    s_add_u32 m0, s92, 0
    s_add_u32 s87, s87, 98304
    s_cmp_ge_u32 s87, 4718592
    s_cselect_b32 s55, 4718592, 0
    s_sub_u32 s87, s87, s55
    buffer_load_dwordx4 v5, s[32:35], s87 offen offset:0 lds
    buffer_load_dwordx4 v6, s[32:35], s87 offen offset:1024 lds
    buffer_load_dwordx4 v7, s[32:35], s87 offen offset:2048 lds
    buffer_load_dwordx4 v8, s[32:35], s87 offen offset:3072 lds
    s_waitcnt vmcnt(13)
    s_waitcnt lgkmcnt(7)
    ds_read_b64_tr_b16 a[64:65], v9 offset:16384
    ds_read_b64_tr_b16 a[66:67], v11 offset:16896
    ds_read_b64_tr_b16 a[68:69], v10 offset:16384
    ds_read_b64_tr_b16 a[70:71], v12 offset:16896
    ds_read_b64_tr_b16 a[72:73], v11 offset:16384
    ds_read_b64_tr_b16 a[74:75], v9 offset:16896
    ds_read_b64_tr_b16 a[76:77], v12 offset:16384
    ds_read_b64_tr_b16 a[78:79], v10 offset:16896
    s_add_u32 m0, s92, 4096
    s_add_u32 s87, s87, 98304
    s_cmp_ge_u32 s87, 4718592
    s_cselect_b32 s55, 4718592, 0
    s_sub_u32 s87, s87, s55
    buffer_load_dwordx4 v5, s[32:35], s87 offen offset:0 lds
    buffer_load_dwordx4 v6, s[32:35], s87 offen offset:1024 lds
    buffer_load_dwordx4 v7, s[32:35], s87 offen offset:2048 lds
    buffer_load_dwordx4 v8, s[32:35], s87 offen offset:3072 lds
    s_waitcnt vmcnt(13)
    s_waitcnt lgkmcnt(7)
    ds_read_b64_tr_b16 a[80:81], v9 offset:20480
    ds_read_b64_tr_b16 a[82:83], v11 offset:20992
    ds_read_b64_tr_b16 a[84:85], v10 offset:20480
    ds_read_b64_tr_b16 a[86:87], v12 offset:20992
    ds_read_b64_tr_b16 a[88:89], v11 offset:20480
    ds_read_b64_tr_b16 a[90:91], v9 offset:20992
    ds_read_b64_tr_b16 a[92:93], v12 offset:20480
    ds_read_b64_tr_b16 a[94:95], v10 offset:20992
    s_add_u32 m0, s92, 8192
    s_add_u32 s87, s87, 98304
    s_cmp_ge_u32 s87, 4718592
    s_cselect_b32 s55, 4718592, 0
    s_sub_u32 s87, s87, s55
    buffer_load_dwordx4 v5, s[32:35], s87 offen offset:0 lds
    buffer_load_dwordx4 v6, s[32:35], s87 offen offset:1024 lds
    buffer_load_dwordx4 v7, s[32:35], s87 offen offset:2048 lds
    buffer_load_dwordx4 v8, s[32:35], s87 offen offset:3072 lds
    s_waitcnt vmcnt(13)
    s_waitcnt lgkmcnt(7)
    ds_read_b64_tr_b16 a[96:97], v9 offset:24576
    ds_read_b64_tr_b16 a[98:99], v11 offset:25088
    ds_read_b64_tr_b16 a[100:101], v10 offset:24576
    ds_read_b64_tr_b16 a[102:103], v12 offset:25088
    ds_read_b64_tr_b16 a[104:105], v11 offset:24576
    ds_read_b64_tr_b16 a[106:107], v9 offset:25088
    ds_read_b64_tr_b16 a[108:109], v12 offset:24576
    ds_read_b64_tr_b16 a[110:111], v10 offset:25088
    s_add_u32 m0, s92, 12288
    s_add_u32 s87, s87, 98304
    s_cmp_ge_u32 s87, 4718592
    s_cselect_b32 s55, 4718592, 0
    s_sub_u32 s87, s87, s55
    buffer_load_dwordx4 v5, s[32:35], s87 offen offset:0 lds
    buffer_load_dwordx4 v6, s[32:35], s87 offen offset:1024 lds
    buffer_load_dwordx4 v7, s[32:35], s87 offen offset:2048 lds
    buffer_load_dwordx4 v8, s[32:35], s87 offen offset:3072 lds
    s_waitcnt vmcnt(12)
    s_waitcnt lgkmcnt(7)
    ds_read_b64_tr_b16 a[112:113], v9 offset:0
    ds_read_b64_tr_b16 a[114:115], v11 offset:512
    ds_read_b64_tr_b16 a[116:117], v10 offset:0
    ds_read_b64_tr_b16 a[118:119], v12 offset:512
    ds_read_b64_tr_b16 a[120:121], v11 offset:0
    ds_read_b64_tr_b16 a[122:123], v9 offset:512
    ds_read_b64_tr_b16 a[124:125], v12 offset:0
    ds_read_b64_tr_b16 a[126:127], v10 offset:512
    buffer_load_dword v21, v1, s[36:39], s9 offen sc1
    s_add_u32 m0, s92, 16384
    s_add_u32 s87, s87, 98304
    s_cmp_ge_u32 s87, 4718592
    s_cselect_b32 s55, 4718592, 0
    s_sub_u32 s87, s87, s55
    buffer_load_dwordx4 v5, s[32:35], s87 offen offset:0 lds
    buffer_load_dwordx4 v6, s[32:35], s87 offen offset:1024 lds
    buffer_load_dwordx4 v7, s[32:35], s87 offen offset:2048 lds
    buffer_load_dwordx4 v8, s[32:35], s87 offen offset:3072 lds
    s_waitcnt vmcnt(13)
    s_waitcnt lgkmcnt(7)
    ds_read_b64_tr_b16 a[128:129], v9 offset:4096
    ds_read_b64_tr_b16 a[130:131], v11 offset:4608
    ds_read_b64_tr_b16 a[132:133], v10 offset:4096
    ds_read_b64_tr_b16 a[134:135], v12 offset:4608
    ds_read_b64_tr_b16 a[136:137], v11 offset:4096
    ds_read_b64_tr_b16 a[138:139], v9 offset:4608
    ds_read_b64_tr_b16 a[140:141], v12 offset:4096
    ds_read_b64_tr_b16 a[142:143], v10 offset:4608
    s_waitcnt vmcnt(4)
    v_cmp_ne_u32 vcc, 1, v21
    s_cmp_lg_u64 vcc, 0
    s_cbranch_scc1 L_r_sl2
L_r_bk2:
    buffer_load_dwordx4 v[208:211], v4, s[36:39], s44 offen sc1
    buffer_load_dwordx4 v[212:215], v26, s[36:39], s44 offen sc1
    buffer_load_dwordx4 v[216:219], v4, s[36:39], s45 offen sc1
    buffer_load_dwordx4 v[220:223], v26, s[36:39], s45 offen sc1
    buffer_load_dwordx4 v[224:227], v4, s[36:39], s46 offen sc1
    s_waitcnt lgkmcnt(14)
    ds_read_b64_tr_b16 a[144:145], v9 offset:8192
    buffer_load_dwordx4 v[228:231], v26, s[36:39], s46 offen sc1
    s_waitcnt lgkmcnt(1)
    ds_read_b64_tr_b16 a[146:147], v11 offset:8704
    ds_read_b64_tr_b16 a[148:149], v10 offset:8192
    ds_read_b64_tr_b16 a[150:151], v12 offset:8704
    ds_read_b64_tr_b16 a[152:153], v11 offset:8192
    ds_read_b64_tr_b16 a[154:155], v9 offset:8704
    ds_read_b64_tr_b16 a[156:157], v12 offset:8192
    ds_read_b64_tr_b16 a[158:159], v10 offset:8704
    ds_read_b64_tr_b16 a[160:161], v9 offset:12288
    ds_read_b64_tr_b16 a[162:163], v11 offset:12800
    ds_read_b64_tr_b16 a[164:165], v10 offset:12288
    ds_read_b64_tr_b16 a[166:167], v12 offset:12800
    ds_read_b64_tr_b16 a[168:169], v11 offset:12288
    ds_read_b64_tr_b16 a[170:171], v9 offset:12800
    ds_read_b64_tr_b16 a[172:173], v12 offset:12288
    buffer_load_dwordx4 v[232:235], v4, s[36:39], s47 offen sc1
    s_waitcnt lgkmcnt(14)
    ds_read_b64_tr_b16 a[174:175], v10 offset:12800
    buffer_load_dwordx4 v[236:239], v26, s[36:39], s47 offen sc1
    buffer_load_dwordx4 v[240:243], v4, s[36:39], s48 offen sc1
    s_waitcnt vmcnt(9)
    s_waitcnt lgkmcnt(8)
    ds_read_b64_tr_b16 a[176:177], v9 offset:16384
    ds_read_b64_tr_b16 a[178:179], v11 offset:16896
    ds_read_b64_tr_b16 a[180:181], v10 offset:16384
    ds_read_b64_tr_b16 a[182:183], v12 offset:16896
    ds_read_b64_tr_b16 a[184:185], v11 offset:16384
    ds_read_b64_tr_b16 a[186:187], v9 offset:16896
    ds_read_b64_tr_b16 a[188:189], v12 offset:16384
    s_waitcnt lgkmcnt(11)
    ds_read_b64_tr_b16 a[190:191], v10 offset:16896
    buffer_load_dwordx4 v[244:247], v26, s[36:39], s48 offen sc1
    buffer_load_dwordx4 v[248:251], v4, s[36:39], s49 offen sc1
    s_waitcnt vmcnt(10)
    v_mfma_f32_16x16x32_bf16 v[32:35], v[208:211], a[0:3], 0
    buffer_load_dwordx4 v[252:255], v26, s[36:39], s49 offen sc1
    v_mfma_f32_16x16x32_bf16 v[36:39], v[208:211], a[4:7], 0
    v_mfma_f32_16x16x32_bf16 v[40:43], v[208:211], a[8:11], 0
    v_mfma_f32_16x16x32_bf16 v[44:47], v[208:211], a[12:15], 0
    s_waitcnt vmcnt(10)
    v_mfma_f32_16x16x32_bf16 v[48:51], v[212:215], a[0:3], 0
    buffer_load_dwordx4 v[160:163], v4, s[36:39], s50 offen sc1
    v_mfma_f32_16x16x32_bf16 v[52:55], v[212:215], a[4:7], 0
    v_mfma_f32_16x16x32_bf16 v[56:59], v[212:215], a[8:11], 0
    v_mfma_f32_16x16x32_bf16 v[60:63], v[212:215], a[12:15], 0
    s_waitcnt vmcnt(10)
    v_mfma_f32_16x16x32_bf16 v[32:35], v[216:219], a[16:19], v[32:35]
    buffer_load_dwordx4 v[164:167], v26, s[36:39], s50 offen sc1
    v_mfma_f32_16x16x32_bf16 v[36:39], v[216:219], a[20:23], v[36:39]
    v_mfma_f32_16x16x32_bf16 v[40:43], v[216:219], a[24:27], v[40:43]
    v_mfma_f32_16x16x32_bf16 v[44:47], v[216:219], a[28:31], v[44:47]
    s_waitcnt vmcnt(10)
    v_mfma_f32_16x16x32_bf16 v[48:51], v[220:223], a[16:19], v[48:51]
    buffer_load_dwordx4 v[168:171], v4, s[36:39], s51 offen sc1
    v_mfma_f32_16x16x32_bf16 v[52:55], v[220:223], a[20:23], v[52:55]
    v_mfma_f32_16x16x32_bf16 v[56:59], v[220:223], a[24:27], v[56:59]
    v_mfma_f32_16x16x32_bf16 v[60:63], v[220:223], a[28:31], v[60:63]
    s_waitcnt vmcnt(10)
    v_mfma_f32_16x16x32_bf16 v[32:35], v[224:227], a[32:35], v[32:35]
    buffer_load_dwordx4 v[172:175], v26, s[36:39], s51 offen sc1
    v_mfma_f32_16x16x32_bf16 v[36:39], v[224:227], a[36:39], v[36:39]
    v_mfma_f32_16x16x32_bf16 v[40:43], v[224:227], a[40:43], v[40:43]
    v_mfma_f32_16x16x32_bf16 v[44:47], v[224:227], a[44:47], v[44:47]
    s_waitcnt vmcnt(10)
    v_mfma_f32_16x16x32_bf16 v[48:51], v[228:231], a[32:35], v[48:51]
    buffer_load_dwordx4 v[176:179], v4, s[36:39], s74 offen sc1
    v_mfma_f32_16x16x32_bf16 v[52:55], v[228:231], a[36:39], v[52:55]
    v_mfma_f32_16x16x32_bf16 v[56:59], v[228:231], a[40:43], v[56:59]
    v_mfma_f32_16x16x32_bf16 v[60:63], v[228:231], a[44:47], v[60:63]
    s_waitcnt vmcnt(10)
    v_mfma_f32_16x16x32_bf16 v[32:35], v[232:235], a[48:51], v[32:35]
    buffer_load_dwordx4 v[180:183], v26, s[36:39], s74 offen sc1
    v_mfma_f32_16x16x32_bf16 v[36:39], v[232:235], a[52:55], v[36:39]
    v_mfma_f32_16x16x32_bf16 v[40:43], v[232:235], a[56:59], v[40:43]
    v_mfma_f32_16x16x32_bf16 v[44:47], v[232:235], a[60:63], v[44:47]
    s_waitcnt vmcnt(10)
    v_mfma_f32_16x16x32_bf16 v[48:51], v[236:239], a[48:51], v[48:51]
    buffer_load_dwordx4 v[184:187], v4, s[36:39], s75 offen sc1
    v_mfma_f32_16x16x32_bf16 v[52:55], v[236:239], a[52:55], v[52:55]
    v_mfma_f32_16x16x32_bf16 v[56:59], v[236:239], a[56:59], v[56:59]
    v_mfma_f32_16x16x32_bf16 v[60:63], v[236:239], a[60:63], v[60:63]
    s_waitcnt vmcnt(10)
    v_mfma_f32_16x16x32_bf16 v[32:35], v[240:243], a[64:67], v[32:35]
    buffer_load_dwordx4 v[188:191], v4, s[36:39], s76 offen sc1
    v_mfma_f32_16x16x32_bf16 v[36:39], v[240:243], a[68:71], v[36:39]
    v_mfma_f32_16x16x32_bf16 v[40:43], v[240:243], a[72:75], v[40:43]
    v_mfma_f32_16x16x32_bf16 v[44:47], v[240:243], a[76:79], v[44:47]
    s_waitcnt vmcnt(10)
    v_mfma_f32_16x16x32_bf16 v[48:51], v[244:247], a[64:67], v[48:51]
    buffer_load_dwordx4 v[192:195], v4, s[36:39], s77 offen sc1
    v_mfma_f32_16x16x32_bf16 v[52:55], v[244:247], a[68:71], v[52:55]
    v_mfma_f32_16x16x32_bf16 v[56:59], v[244:247], a[72:75], v[56:59]
    v_mfma_f32_16x16x32_bf16 v[60:63], v[244:247], a[76:79], v[60:63]
    s_waitcnt vmcnt(10)
    v_mfma_f32_16x16x32_bf16 v[32:35], v[248:251], a[80:83], v[32:35]
    buffer_load_dwordx4 v[196:199], v26, s[36:39], s75 offen sc1
    v_mfma_f32_16x16x32_bf16 v[36:39], v[248:251], a[84:87], v[36:39]
    v_mfma_f32_16x16x32_bf16 v[40:43], v[248:251], a[88:91], v[40:43]
    v_mfma_f32_16x16x32_bf16 v[44:47], v[248:251], a[92:95], v[44:47]
    s_waitcnt vmcnt(10)
    v_mfma_f32_16x16x32_bf16 v[48:51], v[252:255], a[80:83], v[48:51]
    buffer_load_dwordx4 v[200:203], v26, s[36:39], s76 offen sc1
    v_mfma_f32_16x16x32_bf16 v[52:55], v[252:255], a[84:87], v[52:55]
    v_mfma_f32_16x16x32_bf16 v[56:59], v[252:255], a[88:91], v[56:59]
    v_mfma_f32_16x16x32_bf16 v[60:63], v[252:255], a[92:95], v[60:63]
    s_waitcnt vmcnt(10)
    v_mfma_f32_16x16x32_bf16 v[32:35], v[160:163], a[96:99], v[32:35]
    buffer_load_dwordx4 v[204:207], v26, s[36:39], s77 offen sc1
    v_mfma_f32_16x16x32_bf16 v[36:39], v[160:163], a[100:103], v[36:39]
    v_mfma_f32_16x16x32_bf16 v[40:43], v[160:163], a[104:107], v[40:43]
    v_mfma_f32_16x16x32_bf16 v[44:47], v[160:163], a[108:111], v[44:47]
    s_waitcnt vmcnt(10)
    v_mfma_f32_16x16x32_bf16 v[48:51], v[164:167], a[96:99], v[48:51]
    buffer_load_dwordx4 v[208:211], v27, s[36:39], s44 offen sc1
    v_mfma_f32_16x16x32_bf16 v[52:55], v[164:167], a[100:103], v[52:55]
    v_mfma_f32_16x16x32_bf16 v[56:59], v[164:167], a[104:107], v[56:59]
    v_mfma_f32_16x16x32_bf16 v[60:63], v[164:167], a[108:111], v[60:63]
    s_waitcnt vmcnt(10)
    v_mfma_f32_16x16x32_bf16 v[32:35], v[168:171], a[112:115], v[32:35]
    buffer_load_dwordx4 v[212:215], v27, s[36:39], s45 offen sc1
    v_mfma_f32_16x16x32_bf16 v[36:39], v[168:171], a[116:119], v[36:39]
    v_mfma_f32_16x16x32_bf16 v[40:43], v[168:171], a[120:123], v[40:43]
    v_mfma_f32_16x16x32_bf16 v[44:47], v[168:171], a[124:127], v[44:47]
    s_waitcnt vmcnt(10)
    v_mfma_f32_16x16x32_bf16 v[48:51], v[172:175], a[112:115], v[48:51]
    buffer_load_dwordx4 v[216:219], v27, s[36:39], s46 offen sc1
    v_mfma_f32_16x16x32_bf16 v[52:55], v[172:175], a[116:119], v[52:55]
    v_mfma_f32_16x16x32_bf16 v[56:59], v[172:175], a[120:123], v[56:59]
    v_mfma_f32_16x16x32_bf16 v[60:63], v[172:175], a[124:127], v[60:63]
    s_waitcnt vmcnt(10)
    v_mfma_f32_16x16x32_bf16 v[32:35], v[176:179], a[128:131], v[32:35]
    buffer_load_dwordx4 v[220:223], v27, s[36:39], s47 offen sc1
    v_mfma_f32_16x16x32_bf16 v[36:39], v[176:179], a[132:135], v[36:39]
    v_mfma_f32_16x16x32_bf16 v[40:43], v[176:179], a[136:139], v[40:43]
    v_mfma_f32_16x16x32_bf16 v[44:47], v[176:179], a[140:143], v[44:47]
    s_waitcnt vmcnt(10)
    v_mfma_f32_16x16x32_bf16 v[48:51], v[180:183], a[128:131], v[48:51]
    buffer_load_dwordx4 v[224:227], v27, s[36:39], s48 offen sc1
    v_mfma_f32_16x16x32_bf16 v[52:55], v[180:183], a[132:135], v[52:55]
    v_mfma_f32_16x16x32_bf16 v[56:59], v[180:183], a[136:139], v[56:59]
    v_mfma_f32_16x16x32_bf16 v[60:63], v[180:183], a[140:143], v[60:63]
    s_waitcnt vmcnt(10)
    v_mfma_f32_16x16x32_bf16 v[32:35], v[184:187], a[144:147], v[32:35]
    buffer_load_dwordx4 v[228:231], v27, s[36:39], s49 offen sc1
    v_mfma_f32_16x16x32_bf16 v[36:39], v[184:187], a[148:151], v[36:39]
    v_mfma_f32_16x16x32_bf16 v[40:43], v[184:187], a[152:155], v[40:43]
    v_mfma_f32_16x16x32_bf16 v[44:47], v[184:187], a[156:159], v[44:47]
    s_waitcnt vmcnt(10)
    s_waitcnt lgkmcnt(0)
    v_mfma_f32_16x16x32_bf16 v[32:35], v[188:191], a[160:163], v[32:35]
    buffer_load_dwordx4 v[232:235], v27, s[36:39], s50 offen sc1
    v_mfma_f32_16x16x32_bf16 v[36:39], v[188:191], a[164:167], v[36:39]
    v_mfma_f32_16x16x32_bf16 v[40:43], v[188:191], a[168:171], v[40:43]
    v_mfma_f32_16x16x32_bf16 v[44:47], v[188:191], a[172:175], v[44:47]
    s_waitcnt vmcnt(10)
    v_mfma_f32_16x16x32_bf16 v[36:39], v[192:195], a[180:183], v[36:39]
    buffer_load_dwordx4 v[236:239], v27, s[36:39], s51 offen sc1
    v_mfma_f32_16x16x32_bf16 v[40:43], v[192:195], a[184:187], v[40:43]
    v_mfma_f32_16x16x32_bf16 v[44:47], v[192:195], a[188:191], v[44:47]
    ds_write_b128 v14, v[36:39] offset:12288
    v_mfma_f32_16x16x32_bf16 v[32:35], v[192:195], a[176:179], v[32:35]
    ds_write_b128 v15, v[40:43] offset:12288
    s_waitcnt vmcnt(10)
    v_mfma_f32_16x16x32_bf16 v[48:51], v[196:199], a[144:147], v[48:51]
    ds_write_b128 v16, v[44:47] offset:12288
    buffer_load_dwordx4 v[240:243], v27, s[36:39], s74 offen sc1
    v_mfma_f32_16x16x32_bf16 v[52:55], v[196:199], a[148:151], v[52:55]
    v_mfma_f32_16x16x32_bf16 v[56:59], v[196:199], a[152:155], v[56:59]
    v_mfma_f32_16x16x32_bf16 v[60:63], v[196:199], a[156:159], v[60:63]
    s_waitcnt vmcnt(10)
    v_mfma_f32_16x16x32_bf16 v[48:51], v[200:203], a[160:163], v[48:51]
    buffer_load_dwordx4 v[244:247], v27, s[36:39], s75 offen sc1
    v_mfma_f32_16x16x32_bf16 v[52:55], v[200:203], a[164:167], v[52:55]
    v_mfma_f32_16x16x32_bf16 v[56:59], v[200:203], a[168:171], v[56:59]
    v_mfma_f32_16x16x32_bf16 v[60:63], v[200:203], a[172:175], v[60:63]
    s_waitcnt vmcnt(10)
    v_mfma_f32_16x16x32_bf16 v[52:55], v[204:207], a[180:183], v[52:55]
    buffer_load_dwordx4 v[248:251], v27, s[36:39], s76 offen sc1
    v_mfma_f32_16x16x32_bf16 v[56:59], v[204:207], a[184:187], v[56:59]
    v_mfma_f32_16x16x32_bf16 v[60:63], v[204:207], a[188:191], v[60:63]
    ds_write_b128 v14, v[52:55] offset:24576
    v_mfma_f32_16x16x32_bf16 v[48:51], v[204:207], a[176:179], v[48:51]
    ds_write_b128 v15, v[56:59] offset:24576
    s_waitcnt vmcnt(10)
    v_mfma_f32_16x16x32_bf16 v[64:67], v[208:211], a[0:3], 0
    ds_write_b128 v16, v[60:63] offset:24576
    buffer_load_dwordx4 v[252:255], v27, s[36:39], s77 offen sc1
    v_mfma_f32_16x16x32_bf16 v[68:71], v[208:211], a[4:7], 0
    v_mfma_f32_16x16x32_bf16 v[72:75], v[208:211], a[8:11], 0
    v_mfma_f32_16x16x32_bf16 v[76:79], v[208:211], a[12:15], 0
    s_waitcnt vmcnt(10)
    v_mfma_f32_16x16x32_bf16 v[64:67], v[212:215], a[16:19], v[64:67]
    buffer_load_dwordx4 v[160:163], v30, s[36:39], s44 offen sc1
    v_mfma_f32_16x16x32_bf16 v[68:71], v[212:215], a[20:23], v[68:71]
    v_mfma_f32_16x16x32_bf16 v[72:75], v[212:215], a[24:27], v[72:75]
    v_mfma_f32_16x16x32_bf16 v[76:79], v[212:215], a[28:31], v[76:79]
    s_waitcnt vmcnt(10)
    v_mfma_f32_16x16x32_bf16 v[64:67], v[216:219], a[32:35], v[64:67]
    buffer_load_dwordx4 v[164:167], v30, s[36:39], s45 offen sc1
    s_waitcnt lgkmcnt(0)
    s_barrier
    ds_read_b128 v[112:115], v13 offset:12288
    ds_read_b128 v[116:119], v13 offset:13312
    ds_read_b128 v[120:123], v13 offset:14336
    ds_read_b128 v[124:127], v13 offset:24576
    ds_read_b128 v[128:131], v13 offset:25600
    ds_read_b128 v[132:135], v13 offset:26624
    v_mfma_f32_16x16x32_bf16 v[68:71], v[216:219], a[36:39], v[68:71]
    v_mfma_f32_16x16x32_bf16 v[72:75], v[216:219], a[40:43], v[72:75]
    buffer_load_dwordx4 v[168:171], v30, s[36:39], s46 offen sc1
    v_mfma_f32_16x16x32_bf16 v[76:79], v[216:219], a[44:47], v[76:79]
    s_waitcnt vmcnt(11)
    v_mfma_f32_16x16x32_bf16 v[64:67], v[220:223], a[48:51], v[64:67]
    v_mfma_f32_16x16x32_bf16 v[68:71], v[220:223], a[52:55], v[68:71]
    v_mfma_f32_16x16x32_bf16 v[72:75], v[220:223], a[56:59], v[72:75]
    buffer_load_dwordx4 v[172:175], v30, s[36:39], s47 offen sc1
    v_mfma_f32_16x16x32_bf16 v[76:79], v[220:223], a[60:63], v[76:79]
    s_waitcnt vmcnt(11)
    v_mfma_f32_16x16x32_bf16 v[64:67], v[224:227], a[64:67], v[64:67]
    s_waitcnt lgkmcnt(3)
    v_pk_add_f32 v[32:33], v[32:33], v[112:113]
    v_pk_add_f32 v[116:117], v[116:117], v[120:121]
    v_pk_add_f32 v[34:35], v[34:35], v[114:115]
    v_pk_add_f32 v[118:119], v[118:119], v[122:123]
    v_pk_add_f32 v[32:33], v[32:33], v[116:117]
    v_pk_add_f32 v[34:35], v[34:35], v[118:119]
    v_cvt_pk_bf16_f32 v112, v32, v33
    v_cvt_pk_bf16_f32 v113, v34, v35
    s_waitcnt lgkmcnt(0)
    v_pk_add_f32 v[48:49], v[48:49], v[124:125]
    v_pk_add_f32 v[128:129], v[128:129], v[132:133]
    v_pk_add_f32 v[50:51], v[50:51], v[126:127]
    v_pk_add_f32 v[130:131], v[130:131], v[134:135]
    v_pk_add_f32 v[48:49], v[48:49], v[128:129]
    v_pk_add_f32 v[50:51], v[50:51], v[130:131]
    v_cvt_pk_bf16_f32 v124, v48, v49
    v_cvt_pk_bf16_f32 v125, v50, v51
    buffer_store_dwordx2 v[112:113], v28, s[36:39], s79 offen offset:0 sc1
    buffer_store_dwordx2 v[124:125], v28, s[36:39], s79 offen offset:2048 sc1
    v_mfma_f32_16x16x32_bf16 v[68:71], v[224:227], a[68:71], v[68:71]
    buffer_load_dwordx4 v[176:179], v30, s[36:39], s48 offen sc1
    v_mfma_f32_16x16x32_bf16 v[72:75], v[224:227], a[72:75], v[72:75]
    buffer_load_dwordx4 v[180:183], v30, s[36:39], s49 offen sc1
    v_mfma_f32_16x16x32_bf16 v[76:79], v[224:227], a[76:79], v[76:79]
    s_waitcnt vmcnt(14)
    v_mfma_f32_16x16x32_bf16 v[64:67], v[228:231], a[80:83], v[64:67]
    v_mfma_f32_16x16x32_bf16 v[68:71], v[228:231], a[84:87], v[68:71]
    v_mfma_f32_16x16x32_bf16 v[72:75], v[228:231], a[88:91], v[72:75]
    buffer_load_dwordx4 v[184:187], v30, s[36:39], s50 offen sc1
    v_mfma_f32_16x16x32_bf16 v[76:79], v[228:231], a[92:95], v[76:79]
    s_waitcnt vmcnt(14)
    v_mfma_f32_16x16x32_bf16 v[64:67], v[232:235], a[96:99], v[64:67]
    v_mfma_f32_16x16x32_bf16 v[68:71], v[232:235], a[100:103], v[68:71]
    v_mfma_f32_16x16x32_bf16 v[72:75], v[232:235], a[104:107], v[72:75]
    buffer_load_dwordx4 v[188:191], v30, s[36:39], s51 offen sc1
    v_mfma_f32_16x16x32_bf16 v[76:79], v[232:235], a[108:111], v[76:79]
    s_waitcnt vmcnt(14)
    v_mfma_f32_16x16x32_bf16 v[64:67], v[236:239], a[112:115], v[64:67]
    v_mfma_f32_16x16x32_bf16 v[68:71], v[236:239], a[116:119], v[68:71]
    v_mfma_f32_16x16x32_bf16 v[72:75], v[236:239], a[120:123], v[72:75]
    buffer_load_dwordx4 v[192:195], v30, s[36:39], s74 offen sc1
    v_mfma_f32_16x16x32_bf16 v[76:79], v[236:239], a[124:127], v[76:79]
    s_waitcnt vmcnt(14)
    v_mfma_f32_16x16x32_bf16 v[64:67], v[240:243], a[128:131], v[64:67]
    v_mfma_f32_16x16x32_bf16 v[68:71], v[240:243], a[132:135], v[68:71]
    v_mfma_f32_16x16x32_bf16 v[72:75], v[240:243], a[136:139], v[72:75]
    buffer_load_dwordx4 v[196:199], v30, s[36:39], s75 offen sc1
    v_mfma_f32_16x16x32_bf16 v[76:79], v[240:243], a[140:143], v[76:79]
    s_waitcnt vmcnt(14)
    v_mfma_f32_16x16x32_bf16 v[64:67], v[244:247], a[144:147], v[64:67]
    v_mfma_f32_16x16x32_bf16 v[68:71], v[244:247], a[148:151], v[68:71]
    v_mfma_f32_16x16x32_bf16 v[72:75], v[244:247], a[152:155], v[72:75]
    buffer_load_dwordx4 v[200:203], v30, s[36:39], s76 offen sc1
    v_mfma_f32_16x16x32_bf16 v[76:79], v[244:247], a[156:159], v[76:79]
    s_waitcnt vmcnt(14)
    v_mfma_f32_16x16x32_bf16 v[64:67], v[248:251], a[160:163], v[64:67]
    v_mfma_f32_16x16x32_bf16 v[68:71], v[248:251], a[164:167], v[68:71]
    v_mfma_f32_16x16x32_bf16 v[72:75], v[248:251], a[168:171], v[72:75]
    buffer_load_dwordx4 v[204:207], v30, s[36:39], s77 offen sc1
    v_mfma_f32_16x16x32_bf16 v[76:79], v[248:251], a[172:175], v[76:79]
    s_waitcnt vmcnt(14)
    v_mfma_f32_16x16x32_bf16 v[68:71], v[252:255], a[180:183], v[68:71]
    v_mfma_f32_16x16x32_bf16 v[72:75], v[252:255], a[184:187], v[72:75]
    v_mfma_f32_16x16x32_bf16 v[76:79], v[252:255], a[188:191], v[76:79]
    ds_write_b128 v14, v[68:71] offset:36864
    buffer_load_dwordx4 v[208:211], v31, s[36:39], s44 offen sc1
    s_nop 1
    ds_write_b128 v15, v[72:75] offset:36864
    v_mfma_f32_16x16x32_bf16 v[64:67], v[252:255], a[176:179], v[64:67]
    s_nop 1
    ds_write_b128 v16, v[76:79] offset:36864
    s_waitcnt vmcnt(14)
    v_mfma_f32_16x16x32_bf16 v[80:83], v[160:163], a[0:3], 0
    v_mfma_f32_16x16x32_bf16 v[84:87], v[160:163], a[4:7], 0
    v_mfma_f32_16x16x32_bf16 v[88:91], v[160:163], a[8:11], 0
    buffer_load_dwordx4 v[212:215], v31, s[36:39], s45 offen sc1
    v_mfma_f32_16x16x32_bf16 v[92:95], v[160:163], a[12:15], 0
    s_waitcnt vmcnt(14)
    v_mfma_f32_16x16x32_bf16 v[80:83], v[164:167], a[16:19], v[80:83]
    v_mfma_f32_16x16x32_bf16 v[84:87], v[164:167], a[20:23], v[84:87]
    v_mfma_f32_16x16x32_bf16 v[88:91], v[164:167], a[24:27], v[88:91]
    buffer_load_dwordx4 v[216:219], v31, s[36:39], s46 offen sc1
    buffer_load_dword v22, v17, s[36:39], s14 offen sc1
    v_mfma_f32_16x16x32_bf16 v[92:95], v[164:167], a[28:31], v[92:95]
    s_waitcnt vmcnt(15)
    v_mfma_f32_16x16x32_bf16 v[80:83], v[168:171], a[32:35], v[80:83]
    s_waitcnt lgkmcnt(0)
    s_barrier
    ds_read_b128 v[136:139], v13 offset:36864
    ds_read_b128 v[140:143], v13 offset:37888
    ds_read_b128 v[144:147], v13 offset:38912
    v_mfma_f32_16x16x32_bf16 v[84:87], v[168:171], a[36:39], v[84:87]
    v_mfma_f32_16x16x32_bf16 v[88:91], v[168:171], a[40:43], v[88:91]
    buffer_load_dwordx4 v[220:223], v31, s[36:39], s47 offen sc1
    v_mfma_f32_16x16x32_bf16 v[92:95], v[168:171], a[44:47], v[92:95]
    s_waitcnt vmcnt(15)
    v_mfma_f32_16x16x32_bf16 v[80:83], v[172:175], a[48:51], v[80:83]
    v_mfma_f32_16x16x32_bf16 v[84:87], v[172:175], a[52:55], v[84:87]
    v_mfma_f32_16x16x32_bf16 v[88:91], v[172:175], a[56:59], v[88:91]
    buffer_load_dwordx4 v[224:227], v31, s[36:39], s48 offen sc1
    v_mfma_f32_16x16x32_bf16 v[92:95], v[172:175], a[60:63], v[92:95]
    s_waitcnt lgkmcnt(0)
    v_pk_add_f32 v[64:65], v[64:65], v[136:137]
    v_pk_add_f32 v[140:141], v[140:141], v[144:145]
    v_pk_add_f32 v[66:67], v[66:67], v[138:139]
    v_pk_add_f32 v[142:143], v[142:143], v[146:147]
    v_pk_add_f32 v[64:65], v[64:65], v[140:141]
    v_pk_add_f32 v[66:67], v[66:67], v[142:143]
    v_cvt_pk_bf16_f32 v136, v64, v65
    v_cvt_pk_bf16_f32 v137, v66, v67
    buffer_store_dwordx2 v[136:137], v28, s[36:39], s80 offen offset:0 sc1
    buffer_load_dwordx4 v[228:231], v31, s[36:39], s49 offen sc1
    buffer_load_dwordx4 v[232:235], v31, s[36:39], s50 offen sc1
    buffer_load_dwordx4 v[236:239], v31, s[36:39], s51 offen sc1
    buffer_load_dwordx4 v[240:243], v31, s[36:39], s74 offen sc1
    buffer_load_dwordx4 v[244:247], v31, s[36:39], s75 offen sc1
    buffer_load_dwordx4 v[248:251], v31, s[36:39], s76 offen sc1
    s_waitcnt vmcnt(20)
    v_mfma_f32_16x16x32_bf16 v[80:83], v[176:179], a[64:67], v[80:83]
    v_mfma_f32_16x16x32_bf16 v[84:87], v[176:179], a[68:71], v[84:87]
    v_mfma_f32_16x16x32_bf16 v[88:91], v[176:179], a[72:75], v[88:91]
    v_mfma_f32_16x16x32_bf16 v[92:95], v[176:179], a[76:79], v[92:95]
    buffer_load_dwordx4 v[252:255], v31, s[36:39], s77 offen sc1
    s_waitcnt vmcnt(20)
    v_mfma_f32_16x16x32_bf16 v[80:83], v[180:183], a[80:83], v[80:83]
    v_mfma_f32_16x16x32_bf16 v[84:87], v[180:183], a[84:87], v[84:87]
    v_mfma_f32_16x16x32_bf16 v[88:91], v[180:183], a[88:91], v[88:91]
    v_mfma_f32_16x16x32_bf16 v[92:95], v[180:183], a[92:95], v[92:95]
    s_waitcnt vmcnt(19)
    v_mfma_f32_16x16x32_bf16 v[80:83], v[184:187], a[96:99], v[80:83]
    v_mfma_f32_16x16x32_bf16 v[84:87], v[184:187], a[100:103], v[84:87]
    s_add_u32 m0, s22, 0
    v_mfma_f32_16x16x32_bf16 v[88:91], v[184:187], a[104:107], v[88:91]
    buffer_load_dwordx4 v152, s[36:39], s57 offen offset:0 sc1 lds
    v_mfma_f32_16x16x32_bf16 v[92:95], v[184:187], a[108:111], v[92:95]
    buffer_load_dwordx4 v153, s[36:39], s57 offen offset:1024 sc1 lds
    s_waitcnt vmcnt(14)
    v_mfma_f32_16x16x32_bf16 v[80:83], v[188:191], a[112:115], v[80:83]
    v_mfma_f32_16x16x32_bf16 v[84:87], v[188:191], a[116:119], v[84:87]
    v_mfma_f32_16x16x32_bf16 v[88:91], v[188:191], a[120:123], v[88:91]
    v_mfma_f32_16x16x32_bf16 v[92:95], v[188:191], a[124:127], v[92:95]
    buffer_load_dwordx4 v154, s[36:39], s57 offen offset:2048 sc1 lds
    s_add_u32 m0, s22, 12288
    v_mfma_f32_16x16x32_bf16 v[80:83], v[192:195], a[128:131], v[80:83]
    v_mfma_f32_16x16x32_bf16 v[84:87], v[192:195], a[132:135], v[84:87]
    v_mfma_f32_16x16x32_bf16 v[88:91], v[192:195], a[136:139], v[88:91]
    v_mfma_f32_16x16x32_bf16 v[92:95], v[192:195], a[140:143], v[92:95]
    buffer_load_dwordx4 v152, s[36:39], s58 offen offset:0 sc1 lds
    v_mfma_f32_16x16x32_bf16 v[80:83], v[196:199], a[144:147], v[80:83]
    v_mfma_f32_16x16x32_bf16 v[84:87], v[196:199], a[148:151], v[84:87]
    v_mfma_f32_16x16x32_bf16 v[88:91], v[196:199], a[152:155], v[88:91]
    v_mfma_f32_16x16x32_bf16 v[92:95], v[196:199], a[156:159], v[92:95]
    buffer_load_dwordx4 v153, s[36:39], s58 offen offset:1024 sc1 lds
    v_mfma_f32_16x16x32_bf16 v[80:83], v[200:203], a[160:163], v[80:83]
    v_mfma_f32_16x16x32_bf16 v[84:87], v[200:203], a[164:167], v[84:87]
    v_mfma_f32_16x16x32_bf16 v[88:91], v[200:203], a[168:171], v[88:91]
    v_mfma_f32_16x16x32_bf16 v[92:95], v[200:203], a[172:175], v[92:95]
    buffer_load_dwordx4 v154, s[36:39], s58 offen offset:2048 sc1 lds
    s_add_u32 m0, s22, 24576
    v_mfma_f32_16x16x32_bf16 v[84:87], v[204:207], a[180:183], v[84:87]
    v_mfma_f32_16x16x32_bf16 v[88:91], v[204:207], a[184:187], v[88:91]
    v_mfma_f32_16x16x32_bf16 v[92:95], v[204:207], a[188:191], v[92:95]
    ds_write_b128 v14, v[84:87] offset:0
    v_mfma_f32_16x16x32_bf16 v[80:83], v[204:207], a[176:179], v[80:83]
    ds_write_b128 v15, v[88:91] offset:0
    buffer_load_dwordx4 v152, s[36:39], s59 offen offset:0 sc1 lds
    s_nop 1
    ds_write_b128 v16, v[92:95] offset:0
    v_mfma_f32_16x16x32_bf16 v[96:99], v[208:211], a[0:3], 0
    v_mfma_f32_16x16x32_bf16 v[100:103], v[208:211], a[4:7], 0
    v_mfma_f32_16x16x32_bf16 v[104:107], v[208:211], a[8:11], 0
    v_mfma_f32_16x16x32_bf16 v[108:111], v[208:211], a[12:15], 0
    buffer_load_dwordx4 v153, s[36:39], s59 offen offset:1024 sc1 lds
    v_mfma_f32_16x16x32_bf16 v[96:99], v[212:215], a[16:19], v[96:99]
    v_mfma_f32_16x16x32_bf16 v[100:103], v[212:215], a[20:23], v[100:103]
    v_mfma_f32_16x16x32_bf16 v[104:107], v[212:215], a[24:27], v[104:107]
    v_mfma_f32_16x16x32_bf16 v[108:111], v[212:215], a[28:31], v[108:111]
    s_waitcnt vmcnt(18)
    v_cmp_ne_u32 vcc, 1, v22
    s_cmp_lg_u64 vcc, 0
    s_cbranch_scc1 L_r_sl3
L_r_bk3:
    v_mfma_f32_16x16x32_bf16 v[96:99], v[216:219], a[32:35], v[96:99]
    buffer_load_dwordx4 a[192:195], v148, s[36:39], s57 offen offset:0 sc1
    s_waitcnt lgkmcnt(0)
    s_barrier
    ds_read_b128 v[112:115], v13 offset:0
    ds_read_b128 v[116:119], v13 offset:1024
    ds_read_b128 v[120:123], v13 offset:2048
    v_mfma_f32_16x16x32_bf16 v[100:103], v[216:219], a[36:39], v[100:103]
    buffer_load_dwordx4 a[196:199], v149, s[36:39], s57 offen offset:0 sc1
    v_mfma_f32_16x16x32_bf16 v[104:107], v[216:219], a[40:43], v[104:107]
    v_mfma_f32_16x16x32_bf16 v[108:111], v[216:219], a[44:47], v[108:111]
    s_waitcnt vmcnt(19)
    v_mfma_f32_16x16x32_bf16 v[96:99], v[220:223], a[48:51], v[96:99]
    v_mfma_f32_16x16x32_bf16 v[100:103], v[220:223], a[52:55], v[100:103]
    buffer_load_dwordx4 a[200:203], v148, s[36:39], s57 offen offset:1024 sc1
    v_mfma_f32_16x16x32_bf16 v[104:107], v[220:223], a[56:59], v[104:107]
    v_mfma_f32_16x16x32_bf16 v[108:111], v[220:223], a[60:63], v[108:111]
    s_waitcnt vmcnt(19)
    v_mfma_f32_16x16x32_bf16 v[96:99], v[224:227], a[64:67], v[96:99]
    s_waitcnt lgkmcnt(0)
    v_pk_add_f32 v[80:81], v[80:81], v[112:113]
    v_pk_add_f32 v[116:117], v[116:117], v[120:121]
    v_pk_add_f32 v[82:83], v[82:83], v[114:115]
    v_pk_add_f32 v[118:119], v[118:119], v[122:123]
    v_pk_add_f32 v[80:81], v[80:81], v[116:117]
    v_pk_add_f32 v[82:83], v[82:83], v[118:119]
    v_cvt_pk_bf16_f32 v112, v80, v81
    v_cvt_pk_bf16_f32 v113, v82, v83
    buffer_store_dwordx2 v[112:113], v28, s[36:39], s80 offen offset:2048 sc1
    v_mfma_f32_16x16x32_bf16 v[100:103], v[224:227], a[68:71], v[100:103]
    buffer_load_dwordx4 a[204:207], v149, s[36:39], s57 offen offset:1024 sc1
    v_mfma_f32_16x16x32_bf16 v[104:107], v[224:227], a[72:75], v[104:107]
    v_mfma_f32_16x16x32_bf16 v[108:111], v[224:227], a[76:79], v[108:111]
    s_waitcnt vmcnt(19)
    v_mfma_f32_16x16x32_bf16 v[96:99], v[228:231], a[80:83], v[96:99]
    buffer_load_dwordx4 a[208:211], v148, s[36:39], s58 offen offset:0 sc1
    v_mfma_f32_16x16x32_bf16 v[100:103], v[228:231], a[84:87], v[100:103]
    s_waitcnt vmcnt(11)
    ds_read_b128 v[32:35], v157 offset:0
    v_mfma_f32_16x16x32_bf16 v[104:107], v[228:231], a[88:91], v[104:107]
    ds_read_b128 v[36:39], v157 offset:1024
    ds_read_b128 v[40:43], v157 offset:2048
    v_mfma_f32_16x16x32_bf16 v[108:111], v[228:231], a[92:95], v[108:111]
    v_mfma_f32_16x16x32_bf16 v[96:99], v[232:235], a[96:99], v[96:99]
    buffer_load_dwordx4 a[212:215], v149, s[36:39], s58 offen offset:0 sc1
    v_mfma_f32_16x16x32_bf16 v[100:103], v[232:235], a[100:103], v[100:103]
    v_mfma_f32_16x16x32_bf16 v[104:107], v[232:235], a[104:107], v[104:107]
    v_mfma_f32_16x16x32_bf16 v[108:111], v[232:235], a[108:111], v[108:111]
    v_mfma_f32_16x16x32_bf16 v[96:99], v[236:239], a[112:115], v[96:99]
    buffer_load_dwordx4 a[216:219], v148, s[36:39], s58 offen offset:1024 sc1
    v_mfma_f32_16x16x32_bf16 v[100:103], v[236:239], a[116:119], v[100:103]
    s_waitcnt lgkmcnt(0)
    v_max3_u32 v44, v32, v34, v36
    v_mfma_f32_16x16x32_bf16 v[104:107], v[236:239], a[120:123], v[104:107]
    v_max3_u32 v38, v38, v40, v42
    v_mfma_f32_16x16x32_bf16 v[108:111], v[236:239], a[124:127], v[108:111]
    v_max_u32 v44, v44, v38
    v_mfma_f32_16x16x32_bf16 v[96:99], v[240:243], a[128:131], v[96:99]
    v_cmp_eq_u32 vcc, -1, v44
    buffer_load_dwordx4 a[220:223], v149, s[36:39], s58 offen offset:1024 sc1
    v_mfma_f32_16x16x32_bf16 v[100:103], v[240:243], a[132:135], v[100:103]
    s_cbranch_vccnz L_r_gs0
L_r_gb0:
    s_barrier
    v_mfma_f32_16x16x32_bf16 v[104:107], v[240:243], a[136:139], v[104:107]
    ds_read_b128 v[176:179], v155 offset:0
    ds_read_b128 v[180:183], v155 offset:1024
    v_mfma_f32_16x16x32_bf16 v[108:111], v[240:243], a[140:143], v[108:111]
    ds_read_b128 v[184:187], v155 offset:2048
    ds_read_b128 v[188:191], v155 offset:3072
    v_mfma_f32_16x16x32_bf16 v[96:99], v[244:247], a[144:147], v[96:99]
    ds_read_b128 v[192:195], v155 offset:4096
    ds_read_b128 v[196:199], v155 offset:5120
    v_mfma_f32_16x16x32_bf16 v[100:103], v[244:247], a[148:151], v[100:103]
    ds_read_b128 v[200:203], v155 offset:6144
    ds_read_b128 v[204:207], v155 offset:7168
    v_mfma_f32_16x16x32_bf16 v[104:107], v[244:247], a[152:155], v[104:107]
    s_waitcnt vmcnt(11)
    ds_read_b128 v[32:35], v157 offset:12288
    v_mfma_f32_16x16x32_bf16 v[108:111], v[244:247], a[156:159], v[108:111]
    ds_read_b128 v[36:39], v157 offset:13312
    ds_read_b128 v[40:43], v157 offset:14336
    v_mfma_f32_16x16x32_bf16 v[96:99], v[248:251], a[160:163], v[96:99]
    buffer_load_dwordx4 v154, s[36:39], s59 offen offset:2048 sc1 lds
    s_add_u32 m0, s22, 36864
    v_mfma_f32_16x16x32_bf16 v[100:103], v[248:251], a[164:167], v[100:103]
    buffer_load_dwordx4 a[224:227], v148, s[36:39], s59 offen offset:0 sc1
    v_mfma_f32_16x16x32_bf16 v[104:107], v[248:251], a[168:171], v[104:107]
    v_mfma_f32_16x16x32_bf16 v[108:111], v[248:251], a[172:175], v[108:111]
    v_mfma_f32_16x16x32_bf16 v[100:103], v[252:255], a[180:183], v[100:103]
    buffer_load_dwordx4 a[228:231], v149, s[36:39], s59 offen offset:0 sc1
    v_mfma_f32_16x16x32_bf16 v[104:107], v[252:255], a[184:187], v[104:107]
    v_mfma_f32_16x16x32_bf16 v[108:111], v[252:255], a[188:191], v[108:111]
    ds_write_b128 v14, v[100:103] offset:12288
    v_mfma_f32_16x16x32_bf16 v[96:99], v[252:255], a[176:179], v[96:99]
    ds_write_b128 v15, v[104:107] offset:12288
    s_waitcnt lgkmcnt(5)
    s_waitcnt vmcnt(11)
    v_mfma_f32_16x16x32_bf16 v[208:211], v[176:179], a[192:195], 0
    ds_write_b128 v16, v[108:111] offset:12288
    buffer_load_dwordx4 a[232:235], v148, s[36:39], s59 offen offset:1024 sc1
    s_waitcnt lgkmcnt(3)
    v_max3_u32 v44, v32, v34, v36
    s_waitcnt vmcnt(11)
    v_mfma_f32_16x16x32_bf16 v[212:215], v[176:179], a[196:199], 0
    ds_read_b128 v[176:179], v155 offset:8192
    v_max3_u32 v38, v38, v40, v42
    v_mfma_f32_16x16x32_bf16 v[216:219], v[180:183], a[192:195], 0
    v_max_u32 v44, v44, v38
    v_mfma_f32_16x16x32_bf16 v[220:223], v[180:183], a[196:199], 0
    ds_read_b128 v[180:183], v155 offset:9216
    v_cmp_eq_u32 vcc, -1, v44
    v_mfma_f32_16x16x32_bf16 v[224:227], v[184:187], a[192:195], 0
    s_cbranch_vccnz L_r_gs1
L_r_gb1:
    s_barrier
    v_mfma_f32_16x16x32_bf16 v[228:231], v[184:187], a[196:199], 0
    ds_read_b128 v[184:187], v155 offset:10240
    buffer_load_dwordx4 a[236:239], v149, s[36:39], s59 offen offset:1024 sc1
    v_mfma_f32_16x16x32_bf16 v[232:235], v[188:191], a[192:195], 0
    v_mfma_f32_16x16x32_bf16 v[236:239], v[188:191], a[196:199], 0
    s_waitcnt lgkmcnt(3)
    s_barrier
    ds_read_b128 v[124:127], v13 offset:12288
    ds_read_b128 v[128:131], v13 offset:13312
    ds_read_b128 v[132:135], v13 offset:14336
    v_mfma_f32_16x16x32_bf16 v[240:243], v[192:195], a[192:195], 0
    ds_read_b128 v[188:191], v155 offset:11264
    buffer_load_dwordx4 v152, s[36:39], s60 offen offset:0 sc1 lds
    v_mfma_f32_16x16x32_bf16 v[244:247], v[192:195], a[196:199], 0
    ds_read_b128 v[192:195], v155 offset:12288
    v_mfma_f32_16x16x32_bf16 v[248:251], v[196:199], a[192:195], 0
    buffer_load_dwordx4 v153, s[36:39], s60 offen offset:1024 sc1 lds
    v_mfma_f32_16x16x32_bf16 v[252:255], v[196:199], a[196:199], 0
    ds_read_b128 v[196:199], v155 offset:13312
    s_waitcnt vmcnt(13)
    v_mfma_f32_16x16x32_bf16 v[208:211], v[200:203], a[200:203], v[208:211]
    buffer_load_dwordx4 v154, s[36:39], s60 offen offset:2048 sc1 lds
    s_add_u32 m0, s22, 49152
    s_waitcnt lgkmcnt(3)
    v_pk_add_f32 v[96:97], v[96:97], v[124:125]
    v_pk_add_f32 v[128:129], v[128:129], v[132:133]
    v_pk_add_f32 v[98:99], v[98:99], v[126:127]
    v_pk_add_f32 v[130:131], v[130:131], v[134:135]
    v_pk_add_f32 v[96:97], v[96:97], v[128:129]
    v_pk_add_f32 v[98:99], v[98:99], v[130:131]
    v_cvt_pk_bf16_f32 v124, v96, v97
    v_cvt_pk_bf16_f32 v125, v98, v99
    buffer_store_dwordx2 v[124:125], v28, s[36:39], s81 offen offset:0 sc1
    buffer_load_dwordx4 a[240:243], v148, s[36:39], s60 offen offset:0 sc1
    buffer_load_dwordx4 a[244:247], v149, s[36:39], s60 offen offset:0 sc1
    buffer_load_dwordx4 a[248:251], v148, s[36:39], s60 offen offset:1024 sc1
    buffer_load_dwordx4 a[252:255], v149, s[36:39], s60 offen offset:1024 sc1
    buffer_load_dwordx4 v152, s[36:39], s61 offen offset:0 sc1 lds
    buffer_load_dwordx4 v153, s[36:39], s61 offen offset:1024 sc1 lds
    s_waitcnt vmcnt(19)
    v_mfma_f32_16x16x32_bf16 v[212:215], v[200:203], a[204:207], v[212:215]
    ds_read_b128 v[200:203], v155 offset:14336
    s_waitcnt vmcnt(14)
    ds_read_b128 v[32:35], v157 offset:24576
    v_mfma_f32_16x16x32_bf16 v[216:219], v[204:207], a[200:203], v[216:219]
    ds_read_b128 v[36:39], v157 offset:25600
    ds_read_b128 v[40:43], v157 offset:26624
    v_mfma_f32_16x16x32_bf16 v[220:223], v[204:207], a[204:207], v[220:223]
    ds_read_b128 v[204:207], v155 offset:15360
    buffer_load_dwordx4 v154, s[36:39], s61 offen offset:2048 sc1 lds
    s_add_u32 m0, s22, 61440
    v_mfma_f32_16x16x32_bf16 v[224:227], v[176:179], a[200:203], v[224:227]
    v_mfma_f32_16x16x32_bf16 v[228:231], v[176:179], a[204:207], v[228:231]
    ds_read_b128 v[176:179], v155 offset:16384
    v_mfma_f32_16x16x32_bf16 v[232:235], v[180:183], a[200:203], v[232:235]
    v_mfma_f32_16x16x32_bf16 v[236:239], v[180:183], a[204:207], v[236:239]
    ds_read_b128 v[180:183], v155 offset:17408
    buffer_load_dwordx4 a[0:3], v148, s[36:39], s61 offen offset:0 sc1
    v_mfma_f32_16x16x32_bf16 v[240:243], v[184:187], a[200:203], v[240:243]
    v_mfma_f32_16x16x32_bf16 v[244:247], v[184:187], a[204:207], v[244:247]
    ds_read_b128 v[184:187], v155 offset:18432
    s_waitcnt lgkmcnt(4)
    v_max3_u32 v44, v32, v34, v36
    v_mfma_f32_16x16x32_bf16 v[248:251], v[188:191], a[200:203], v[248:251]
    v_max3_u32 v38, v38, v40, v42
    buffer_load_dwordx4 a[4:7], v149, s[36:39], s61 offen offset:0 sc1
    v_mfma_f32_16x16x32_bf16 v[252:255], v[188:191], a[204:207], v[252:255]
    ds_read_b128 v[188:191], v155 offset:19456
    v_max_u32 v44, v44, v38
    v_mfma_f32_16x16x32_bf16 v[208:211], v[192:195], a[208:211], v[208:211]
    v_cmp_eq_u32 vcc, -1, v44
    v_mfma_f32_16x16x32_bf16 v[212:215], v[192:195], a[212:215], v[212:215]
    ds_read_b128 v[192:195], v155 offset:20480
    v_mfma_f32_16x16x32_bf16 v[216:219], v[196:199], a[208:211], v[216:219]
    s_cbranch_vccnz L_r_gs2
L_r_gb2:
    s_barrier
    v_mfma_f32_16x16x32_bf16 v[220:223], v[196:199], a[212:215], v[220:223]
    ds_read_b128 v[196:199], v155 offset:21504
    buffer_load_dwordx4 a[8:11], v148, s[36:39], s61 offen offset:1024 sc1
    v_mfma_f32_16x16x32_bf16 v[224:227], v[200:203], a[208:211], v[224:227]
    s_waitcnt vmcnt(11)
    ds_read_b128 v[32:35], v157 offset:36864
    v_mfma_f32_16x16x32_bf16 v[228:231], v[200:203], a[212:215], v[228:231]
    ds_read_b128 v[200:203], v155 offset:22528
    ds_read_b128 v[36:39], v157 offset:37888
    s_waitcnt lgkmcnt(5)
    v_mfma_f32_16x16x32_bf16 v[232:235], v[204:207], a[208:211], v[232:235]
    ds_read_b128 v[40:43], v157 offset:38912
    buffer_load_dwordx4 a[12:15], v149, s[36:39], s61 offen offset:1024 sc1
    v_mfma_f32_16x16x32_bf16 v[236:239], v[204:207], a[212:215], v[236:239]
    ds_read_b128 v[204:207], v155 offset:23552
    v_mfma_f32_16x16x32_bf16 v[240:243], v[176:179], a[208:211], v[240:243]
    v_mfma_f32_16x16x32_bf16 v[244:247], v[176:179], a[212:215], v[244:247]
    ds_read_b128 v[176:179], v155 offset:24576
    v_mfma_f32_16x16x32_bf16 v[248:251], v[180:183], a[208:211], v[248:251]
    buffer_load_dwordx4 v152, s[36:39], s62 offen offset:0 sc1 lds
    v_mfma_f32_16x16x32_bf16 v[252:255], v[180:183], a[212:215], v[252:255]
    ds_read_b128 v[180:183], v155 offset:25600
    v_mfma_f32_16x16x32_bf16 v[208:211], v[184:187], a[216:219], v[208:211]
    v_mfma_f32_16x16x32_bf16 v[212:215], v[184:187], a[220:223], v[212:215]
    ds_read_b128 v[184:187], v155 offset:26624
    s_waitcnt lgkmcnt(4)
    v_max3_u32 v44, v32, v34, v36
    v_mfma_f32_16x16x32_bf16 v[216:219], v[188:191], a[216:219], v[216:219]
    v_max3_u32 v38, v38, v40, v42
    buffer_load_dwordx4 v153, s[36:39], s62 offen offset:1024 sc1 lds
    v_mfma_f32_16x16x32_bf16 v[220:223], v[188:191], a[220:223], v[220:223]
    ds_read_b128 v[188:191], v155 offset:27648
    v_max_u32 v44, v44, v38
    v_mfma_f32_16x16x32_bf16 v[224:227], v[192:195], a[216:219], v[224:227]
    v_cmp_eq_u32 vcc, -1, v44
    v_mfma_f32_16x16x32_bf16 v[228:231], v[192:195], a[220:223], v[228:231]
    ds_read_b128 v[192:195], v155 offset:28672
    v_mfma_f32_16x16x32_bf16 v[232:235], v[196:199], a[216:219], v[232:235]
    s_cbranch_vccnz L_r_gs3
L_r_gb3:
    s_barrier
    v_mfma_f32_16x16x32_bf16 v[236:239], v[196:199], a[220:223], v[236:239]
    ds_read_b128 v[196:199], v155 offset:29696
    buffer_load_dwordx4 v154, s[36:39], s62 offen offset:2048 sc1 lds
    s_add_u32 m0, s22, 73728
    v_mfma_f32_16x16x32_bf16 v[240:243], v[200:203], a[216:219], v[240:243]
    v_mfma_f32_16x16x32_bf16 v[244:247], v[200:203], a[220:223], v[244:247]
    ds_read_b128 v[200:203], v155 offset:30720
    buffer_load_dwordx4 a[16:19], v148, s[36:39], s62 offen offset:0 sc1
    s_waitcnt lgkmcnt(3)
    v_mfma_f32_16x16x32_bf16 v[248:251], v[204:207], a[216:219], v[248:251]
    v_mfma_f32_16x16x32_bf16 v[252:255], v[204:207], a[220:223], v[252:255]
    ds_read_b128 v[204:207], v155 offset:31744
    v_mfma_f32_16x16x32_bf16 v[208:211], v[176:179], a[224:227], v[208:211]
    v_mfma_f32_16x16x32_bf16 v[212:215], v[176:179], a[228:231], v[212:215]
    ds_read_b128 v[176:179], v155 offset:32768
    buffer_load_dwordx4 a[20:23], v149, s[36:39], s62 offen offset:0 sc1
    v_mfma_f32_16x16x32_bf16 v[216:219], v[180:183], a[224:227], v[216:219]
    v_mfma_f32_16x16x32_bf16 v[220:223], v[180:183], a[228:231], v[220:223]
    ds_read_b128 v[180:183], v155 offset:33792
    v_mfma_f32_16x16x32_bf16 v[224:227], v[184:187], a[224:227], v[224:227]
    v_mfma_f32_16x16x32_bf16 v[228:231], v[184:187], a[228:231], v[228:231]
    ds_read_b128 v[184:187], v155 offset:34816
    buffer_load_dwordx4 a[24:27], v148, s[36:39], s62 offen offset:1024 sc1
    v_mfma_f32_16x16x32_bf16 v[232:235], v[188:191], a[224:227], v[232:235]
    v_mfma_f32_16x16x32_bf16 v[236:239], v[188:191], a[228:231], v[236:239]
    ds_read_b128 v[188:191], v155 offset:35840
    s_waitcnt lgkmcnt(3)
    v_mfma_f32_16x16x32_bf16 v[240:243], v[192:195], a[224:227], v[240:243]
    v_mfma_f32_16x16x32_bf16 v[244:247], v[192:195], a[228:231], v[244:247]
    ds_read_b128 v[192:195], v155 offset:36864
    buffer_load_dwordx4 a[28:31], v149, s[36:39], s62 offen offset:1024 sc1
    v_mfma_f32_16x16x32_bf16 v[248:251], v[196:199], a[224:227], v[248:251]
    v_mfma_f32_16x16x32_bf16 v[252:255], v[196:199], a[228:231], v[252:255]
    ds_read_b128 v[196:199], v155 offset:37888
    v_mfma_f32_16x16x32_bf16 v[208:211], v[200:203], a[232:235], v[208:211]
    v_mfma_f32_16x16x32_bf16 v[212:215], v[200:203], a[236:239], v[212:215]
    ds_read_b128 v[200:203], v155 offset:38912
    buffer_load_dwordx4 v152, s[36:39], s63 offen offset:0 sc1 lds
    v_mfma_f32_16x16x32_bf16 v[216:219], v[204:207], a[232:235], v[216:219]
    v_mfma_f32_16x16x32_bf16 v[220:223], v[204:207], a[236:239], v[220:223]
    ds_read_b128 v[204:207], v155 offset:39936
    v_mfma_f32_16x16x32_bf16 v[224:227], v[176:179], a[232:235], v[224:227]
    v_mfma_f32_16x16x32_bf16 v[228:231], v[176:179], a[236:239], v[228:231]
    ds_read_b128 v[176:179], v155 offset:40960
    s_waitcnt vmcnt(12)
    ds_read_b128 v[32:35], v157 offset:49152
    s_waitcnt lgkmcnt(4)
    v_mfma_f32_16x16x32_bf16 v[232:235], v[180:183], a[232:235], v[232:235]
    ds_read_b128 v[36:39], v157 offset:50176
    ds_read_b128 v[40:43], v157 offset:51200
    v_mfma_f32_16x16x32_bf16 v[236:239], v[180:183], a[236:239], v[236:239]
    ds_read_b128 v[180:183], v155 offset:41984
    buffer_load_dwordx4 v153, s[36:39], s63 offen offset:1024 sc1 lds
    v_mfma_f32_16x16x32_bf16 v[240:243], v[184:187], a[232:235], v[240:243]
    v_mfma_f32_16x16x32_bf16 v[244:247], v[184:187], a[236:239], v[244:247]
    ds_read_b128 v[184:187], v155 offset:43008
    buffer_load_dwordx4 v154, s[36:39], s63 offen offset:2048 sc1 lds
    s_add_u32 m0, s22, 86016
    v_mfma_f32_16x16x32_bf16 v[248:251], v[188:191], a[232:235], v[248:251]
    v_mfma_f32_16x16x32_bf16 v[252:255], v[188:191], a[236:239], v[252:255]
    ds_read_b128 v[188:191], v155 offset:44032
    v_mfma_f32_16x16x32_bf16 v[208:211], v[192:195], a[240:243], v[208:211]
    buffer_load_dwordx4 a[32:35], v148, s[36:39], s63 offen offset:0 sc1
    v_mfma_f32_16x16x32_bf16 v[212:215], v[192:195], a[244:247], v[212:215]
    ds_read_b128 v[192:195], v155 offset:45056
    s_waitcnt lgkmcnt(4)
    v_max3_u32 v44, v32, v34, v36
    v_mfma_f32_16x16x32_bf16 v[216:219], v[196:199], a[240:243], v[216:219]
    v_max3_u32 v38, v38, v40, v42
    v_mfma_f32_16x16x32_bf16 v[220:223], v[196:199], a[244:247], v[220:223]
    ds_read_b128 v[196:199], v155 offset:46080
    v_max_u32 v44, v44, v38
    v_mfma_f32_16x16x32_bf16 v[224:227], v[200:203], a[240:243], v[224:227]
    v_cmp_eq_u32 vcc, -1, v44
    buffer_load_dwordx4 a[36:39], v149, s[36:39], s63 offen offset:0 sc1
    v_mfma_f32_16x16x32_bf16 v[228:231], v[200:203], a[244:247], v[228:231]
    ds_read_b128 v[200:203], v155 offset:47104
    v_mfma_f32_16x16x32_bf16 v[232:235], v[204:207], a[240:243], v[232:235]
    s_cbranch_vccnz L_r_gs4
L_r_gb4:
    s_barrier
    v_mfma_f32_16x16x32_bf16 v[236:239], v[204:207], a[244:247], v[236:239]
    ds_read_b128 v[204:207], v155 offset:48128
    v_mfma_f32_16x16x32_bf16 v[240:243], v[176:179], a[240:243], v[240:243]
    buffer_load_dwordx4 a[40:43], v148, s[36:39], s63 offen offset:1024 sc1
    v_mfma_f32_16x16x32_bf16 v[244:247], v[176:179], a[244:247], v[244:247]
    ds_read_b128 v[176:179], v155 offset:49152
    s_waitcnt lgkmcnt(3)
    v_mfma_f32_16x16x32_bf16 v[248:251], v[180:183], a[240:243], v[248:251]
    v_mfma_f32_16x16x32_bf16 v[252:255], v[180:183], a[244:247], v[252:255]
    ds_read_b128 v[180:183], v155 offset:50176
    v_mfma_f32_16x16x32_bf16 v[208:211], v[184:187], a[248:251], v[208:211]
    s_waitcnt vmcnt(10)
    ds_read_b128 v[32:35], v158 offset:0
    v_mfma_f32_16x16x32_bf16 v[212:215], v[184:187], a[252:255], v[212:215]
    ds_read_b128 v[184:187], v155 offset:51200
    ds_read_b128 v[36:39], v158 offset:1024
    v_mfma_f32_16x16x32_bf16 v[216:219], v[188:191], a[248:251], v[216:219]
    ds_read_b128 v[40:43], v158 offset:2048
    buffer_load_dwordx4 a[44:47], v149, s[36:39], s63 offen offset:1024 sc1
    v_mfma_f32_16x16x32_bf16 v[220:223], v[188:191], a[252:255], v[220:223]
    ds_read_b128 v[188:191], v155 offset:52224
    v_mfma_f32_16x16x32_bf16 v[224:227], v[192:195], a[248:251], v[224:227]
    buffer_load_dwordx4 v152, s[36:39], s64 offen offset:0 sc1 lds
    v_mfma_f32_16x16x32_bf16 v[228:231], v[192:195], a[252:255], v[228:231]
    ds_read_b128 v[192:195], v155 offset:53248
    v_mfma_f32_16x16x32_bf16 v[232:235], v[196:199], a[248:251], v[232:235]
    v_mfma_f32_16x16x32_bf16 v[236:239], v[196:199], a[252:255], v[236:239]
    ds_read_b128 v[196:199], v155 offset:54272
    s_waitcnt lgkmcnt(5)
    v_mfma_f32_16x16x32_bf16 v[240:243], v[200:203], a[248:251], v[240:243]
    buffer_load_dwordx4 v153, s[36:39], s64 offen offset:1024 sc1 lds
    v_mfma_f32_16x16x32_bf16 v[244:247], v[200:203], a[252:255], v[244:247]
    ds_read_b128 v[200:203], v155 offset:55296
    s_waitcnt lgkmcnt(4)
    v_max3_u32 v44, v32, v34, v36
    v_mfma_f32_16x16x32_bf16 v[248:251], v[204:207], a[248:251], v[248:251]
    v_max3_u32 v38, v38, v40, v42
    v_mfma_f32_16x16x32_bf16 v[252:255], v[204:207], a[252:255], v[252:255]
    ds_read_b128 v[204:207], v155 offset:56320
    v_max_u32 v44, v44, v38
    v_mfma_f32_16x16x32_bf16 v[208:211], v[176:179], a[0:3], v[208:211]
    v_cmp_eq_u32 vcc, -1, v44
    buffer_load_dwordx4 v154, s[36:39], s64 offen offset:2048 sc1 lds
    s_add_u32 m0, s22, 98304
    v_mfma_f32_16x16x32_bf16 v[212:215], v[176:179], a[4:7], v[212:215]
    ds_read_b128 v[176:179], v155 offset:57344
    v_mfma_f32_16x16x32_bf16 v[216:219], v[180:183], a[0:3], v[216:219]
    s_cbranch_vccnz L_r_gs5
L_r_gb5:
    s_barrier
    v_mfma_f32_16x16x32_bf16 v[220:223], v[180:183], a[4:7], v[220:223]
    ds_read_b128 v[180:183], v155 offset:58368
    v_mfma_f32_16x16x32_bf16 v[224:227], v[184:187], a[0:3], v[224:227]
    buffer_load_dwordx4 a[48:51], v148, s[36:39], s64 offen offset:0 sc1
    v_mfma_f32_16x16x32_bf16 v[228:231], v[184:187], a[4:7], v[228:231]
    ds_read_b128 v[184:187], v155 offset:59392
    s_waitcnt lgkmcnt(3)
    v_mfma_f32_16x16x32_bf16 v[232:235], v[188:191], a[0:3], v[232:235]
    v_mfma_f32_16x16x32_bf16 v[236:239], v[188:191], a[4:7], v[236:239]
    ds_read_b128 v[188:191], v155 offset:60416
    v_mfma_f32_16x16x32_bf16 v[240:243], v[192:195], a[0:3], v[240:243]
    buffer_load_dwordx4 a[52:55], v149, s[36:39], s64 offen offset:0 sc1
    v_mfma_f32_16x16x32_bf16 v[244:247], v[192:195], a[4:7], v[244:247]
    ds_read_b128 v[192:195], v156 offset:0
    v_mfma_f32_16x16x32_bf16 v[248:251], v[196:199], a[0:3], v[248:251]
    v_mfma_f32_16x16x32_bf16 v[252:255], v[196:199], a[4:7], v[252:255]
    ds_read_b128 v[196:199], v156 offset:1024
    v_mfma_f32_16x16x32_bf16 v[208:211], v[200:203], a[8:11], v[208:211]
    buffer_load_dwordx4 a[56:59], v148, s[36:39], s64 offen offset:1024 sc1
    v_mfma_f32_16x16x32_bf16 v[212:215], v[200:203], a[12:15], v[212:215]
    ds_read_b128 v[200:203], v156 offset:2048
    v_mfma_f32_16x16x32_bf16 v[216:219], v[204:207], a[8:11], v[216:219]
    v_mfma_f32_16x16x32_bf16 v[220:223], v[204:207], a[12:15], v[220:223]
    ds_read_b128 v[204:207], v156 offset:3072
    s_waitcnt lgkmcnt(4)
    v_mfma_f32_16x16x32_bf16 v[224:227], v[176:179], a[8:11], v[224:227]
    s_waitcnt vmcnt(10)
    ds_read_b128 v[32:35], v158 offset:12288
    v_mfma_f32_16x16x32_bf16 v[228:231], v[176:179], a[12:15], v[228:231]
    ds_read_b128 v[176:179], v156 offset:4096
    ds_read_b128 v[36:39], v158 offset:13312
    v_mfma_f32_16x16x32_bf16 v[232:235], v[180:183], a[8:11], v[232:235]
    ds_read_b128 v[40:43], v158 offset:14336
    buffer_load_dwordx4 a[60:63], v149, s[36:39], s64 offen offset:1024 sc1
    v_mfma_f32_16x16x32_bf16 v[236:239], v[180:183], a[12:15], v[236:239]
    ds_read_b128 v[180:183], v156 offset:5120
    v_mfma_f32_16x16x32_bf16 v[240:243], v[184:187], a[8:11], v[240:243]
    buffer_load_dwordx4 v152, s[36:39], s65 offen offset:0 sc1 lds
    v_mfma_f32_16x16x32_bf16 v[244:247], v[184:187], a[12:15], v[244:247]
    ds_read_b128 v[184:187], v156 offset:6144
    v_mfma_f32_16x16x32_bf16 v[248:251], v[188:191], a[8:11], v[248:251]
    v_mfma_f32_16x16x32_bf16 v[252:255], v[188:191], a[12:15], v[252:255]
    ds_read_b128 v[188:191], v156 offset:7168
    s_waitcnt lgkmcnt(5)
    v_mfma_f32_16x16x32_bf16 v[208:211], v[192:195], a[16:19], v[208:211]
    buffer_load_dwordx4 v153, s[36:39], s65 offen offset:1024 sc1 lds
    v_mfma_f32_16x16x32_bf16 v[212:215], v[192:195], a[20:23], v[212:215]
    ds_read_b128 v[192:195], v156 offset:8192
    s_waitcnt lgkmcnt(4)
    v_max3_u32 v44, v32, v34, v36
    v_mfma_f32_16x16x32_bf16 v[216:219], v[196:199], a[16:19], v[216:219]
    v_max3_u32 v38, v38, v40, v42
    v_mfma_f32_16x16x32_bf16 v[220:223], v[196:199], a[20:23], v[220:223]
    ds_read_b128 v[196:199], v156 offset:9216
    v_max_u32 v44, v44, v38
    v_mfma_f32_16x16x32_bf16 v[224:227], v[200:203], a[16:19], v[224:227]
    v_cmp_eq_u32 vcc, -1, v44
    buffer_load_dwordx4 v154, s[36:39], s65 offen offset:2048 sc1 lds
    s_add_u32 m0, s22, 110592
    v_mfma_f32_16x16x32_bf16 v[228:231], v[200:203], a[20:23], v[228:231]
    ds_read_b128 v[200:203], v156 offset:10240
    v_mfma_f32_16x16x32_bf16 v[232:235], v[204:207], a[16:19], v[232:235]
    s_cbranch_vccnz L_r_gs6
L_r_gb6:
    s_barrier
    v_mfma_f32_16x16x32_bf16 v[236:239], v[204:207], a[20:23], v[236:239]
    ds_read_b128 v[204:207], v156 offset:11264
    v_mfma_f32_16x16x32_bf16 v[240:243], v[176:179], a[16:19], v[240:243]
    buffer_load_dwordx4 a[64:67], v148, s[36:39], s65 offen offset:0 sc1
    v_mfma_f32_16x16x32_bf16 v[244:247], v[176:179], a[20:23], v[244:247]
    ds_read_b128 v[176:179], v156 offset:12288
    s_waitcnt lgkmcnt(3)
    v_mfma_f32_16x16x32_bf16 v[248:251], v[180:183], a[16:19], v[248:251]
    v_mfma_f32_16x16x32_bf16 v[252:255], v[180:183], a[20:23], v[252:255]
    ds_read_b128 v[180:183], v156 offset:13312
    v_mfma_f32_16x16x32_bf16 v[208:211], v[184:187], a[24:27], v[208:211]
    buffer_load_dwordx4 a[68:71], v149, s[36:39], s65 offen offset:0 sc1
    v_mfma_f32_16x16x32_bf16 v[212:215], v[184:187], a[28:31], v[212:215]
    ds_read_b128 v[184:187], v156 offset:14336
    v_mfma_f32_16x16x32_bf16 v[216:219], v[188:191], a[24:27], v[216:219]
    v_mfma_f32_16x16x32_bf16 v[220:223], v[188:191], a[28:31], v[220:223]
    ds_read_b128 v[188:191], v156 offset:15360
    v_mfma_f32_16x16x32_bf16 v[224:227], v[192:195], a[24:27], v[224:227]
    buffer_load_dwordx4 a[72:75], v148, s[36:39], s65 offen offset:1024 sc1
    v_mfma_f32_16x16x32_bf16 v[228:231], v[192:195], a[28:31], v[228:231]
    ds_read_b128 v[192:195], v156 offset:16384
    v_mfma_f32_16x16x32_bf16 v[232:235], v[196:199], a[24:27], v[232:235]
    v_mfma_f32_16x16x32_bf16 v[236:239], v[196:199], a[28:31], v[236:239]
    ds_read_b128 v[196:199], v156 offset:17408
    s_waitcnt lgkmcnt(4)
    v_mfma_f32_16x16x32_bf16 v[240:243], v[200:203], a[24:27], v[240:243]
    s_waitcnt vmcnt(10)
    ds_read_b128 v[32:35], v158 offset:24576
    v_mfma_f32_16x16x32_bf16 v[244:247], v[200:203], a[28:31], v[244:247]
    ds_read_b128 v[200:203], v156 offset:18432
    ds_read_b128 v[36:39], v158 offset:25600
    v_mfma_f32_16x16x32_bf16 v[248:251], v[204:207], a[24:27], v[248:251]
    ds_read_b128 v[40:43], v158 offset:26624
    buffer_load_dwordx4 a[76:79], v149, s[36:39], s65 offen offset:1024 sc1
    v_mfma_f32_16x16x32_bf16 v[252:255], v[204:207], a[28:31], v[252:255]
    ds_read_b128 v[204:207], v156 offset:19456
    v_mfma_f32_16x16x32_bf16 v[208:211], v[176:179], a[32:35], v[208:211]
    buffer_load_dwordx4 v152, s[36:39], s66 offen offset:0 sc1 lds
    v_mfma_f32_16x16x32_bf16 v[212:215], v[176:179], a[36:39], v[212:215]
    ds_read_b128 v[176:179], v156 offset:20480
    v_mfma_f32_16x16x32_bf16 v[216:219], v[180:183], a[32:35], v[216:219]
    v_mfma_f32_16x16x32_bf16 v[220:223], v[180:183], a[36:39], v[220:223]
    ds_read_b128 v[180:183], v156 offset:21504
    s_waitcnt lgkmcnt(5)
    v_mfma_f32_16x16x32_bf16 v[224:227], v[184:187], a[32:35], v[224:227]
    buffer_load_dwordx4 v153, s[36:39], s66 offen offset:1024 sc1 lds
    v_mfma_f32_16x16x32_bf16 v[228:231], v[184:187], a[36:39], v[228:231]
    ds_read_b128 v[184:187], v156 offset:22528
    s_waitcnt lgkmcnt(4)
    v_max3_u32 v44, v32, v34, v36
    v_mfma_f32_16x16x32_bf16 v[232:235], v[188:191], a[32:35], v[232:235]
    v_max3_u32 v38, v38, v40, v42
    v_mfma_f32_16x16x32_bf16 v[236:239], v[188:191], a[36:39], v[236:239]
    ds_read_b128 v[188:191], v156 offset:23552
    v_max_u32 v44, v44, v38
    v_mfma_f32_16x16x32_bf16 v[240:243], v[192:195], a[32:35], v[240:243]
    v_cmp_eq_u32 vcc, -1, v44
    buffer_load_dwordx4 v154, s[36:39], s66 offen offset:2048 sc1 lds
    v_mfma_f32_16x16x32_bf16 v[244:247], v[192:195], a[36:39], v[244:247]
    s_cbranch_vccnz L_r_gs7
L_r_gb7:
    s_barrier
    v_mfma_f32_16x16x32_bf16 v[248:251], v[196:199], a[32:35], v[248:251]
    ds_read_b128 v[192:195], v156 offset:24576
    v_mfma_f32_16x16x32_bf16 v[252:255], v[196:199], a[36:39], v[252:255]
    ds_read_b128 v[196:199], v156 offset:25600
    v_mfma_f32_16x16x32_bf16 v[208:211], v[200:203], a[40:43], v[208:211]
    buffer_load_dwordx4 a[80:83], v148, s[36:39], s66 offen offset:0 sc1
    v_mfma_f32_16x16x32_bf16 v[212:215], v[200:203], a[44:47], v[212:215]
    ds_read_b128 v[200:203], v156 offset:26624
    s_waitcnt lgkmcnt(3)
    v_mfma_f32_16x16x32_bf16 v[216:219], v[204:207], a[40:43], v[216:219]
    v_mfma_f32_16x16x32_bf16 v[220:223], v[204:207], a[44:47], v[220:223]
    ds_read_b128 v[204:207], v156 offset:27648
    v_mfma_f32_16x16x32_bf16 v[224:227], v[176:179], a[40:43], v[224:227]
    buffer_load_dwordx4 a[84:87], v149, s[36:39], s66 offen offset:0 sc1
    v_mfma_f32_16x16x32_bf16 v[228:231], v[176:179], a[44:47], v[228:231]
    ds_read_b128 v[176:179], v156 offset:28672
    v_mfma_f32_16x16x32_bf16 v[232:235], v[180:183], a[40:43], v[232:235]
    v_mfma_f32_16x16x32_bf16 v[236:239], v[180:183], a[44:47], v[236:239]
    ds_read_b128 v[180:183], v156 offset:29696
    v_mfma_f32_16x16x32_bf16 v[240:243], v[184:187], a[40:43], v[240:243]
    buffer_load_dwordx4 a[88:91], v148, s[36:39], s66 offen offset:1024 sc1
    v_mfma_f32_16x16x32_bf16 v[244:247], v[184:187], a[44:47], v[244:247]
    ds_read_b128 v[184:187], v156 offset:30720
    v_mfma_f32_16x16x32_bf16 v[248:251], v[188:191], a[40:43], v[248:251]
    v_mfma_f32_16x16x32_bf16 v[252:255], v[188:191], a[44:47], v[252:255]
    ds_read_b128 v[188:191], v156 offset:31744
    s_waitcnt lgkmcnt(3)
    s_waitcnt vmcnt(13)
    v_mfma_f32_16x16x32_bf16 v[208:211], v[192:195], a[48:51], v[208:211]
    s_waitcnt vmcnt(10)
    ds_read_b128 v[32:35], v158 offset:36864
    ds_read_b128 v[36:39], v158 offset:37888
    ds_read_b128 v[40:43], v158 offset:38912
    v_mfma_f32_16x16x32_bf16 v[212:215], v[192:195], a[52:55], v[212:215]
    ds_read_b128 v[192:195], v156 offset:32768
    buffer_load_dwordx4 a[92:95], v149, s[36:39], s66 offen offset:1024 sc1
    v_mfma_f32_16x16x32_bf16 v[216:219], v[196:199], a[48:51], v[216:219]
    v_mfma_f32_16x16x32_bf16 v[220:223], v[196:199], a[52:55], v[220:223]
    ds_read_b128 v[196:199], v156 offset:33792
    v_mfma_f32_16x16x32_bf16 v[224:227], v[200:203], a[48:51], v[224:227]
    v_mfma_f32_16x16x32_bf16 v[228:231], v[200:203], a[52:55], v[228:231]
    ds_read_b128 v[200:203], v156 offset:34816
    v_mfma_f32_16x16x32_bf16 v[232:235], v[204:207], a[48:51], v[232:235]
    v_mfma_f32_16x16x32_bf16 v[236:239], v[204:207], a[52:55], v[236:239]
    ds_read_b128 v[204:207], v156 offset:35840
    v_mfma_f32_16x16x32_bf16 v[240:243], v[176:179], a[48:51], v[240:243]
    s_waitcnt lgkmcnt(4)
    v_max3_u32 v44, v32, v34, v36
    v_mfma_f32_16x16x32_bf16 v[244:247], v[176:179], a[52:55], v[244:247]
    v_max3_u32 v38, v38, v40, v42
    v_mfma_f32_16x16x32_bf16 v[248:251], v[180:183], a[48:51], v[248:251]
    v_max_u32 v44, v44, v38
    v_mfma_f32_16x16x32_bf16 v[252:255], v[180:183], a[52:55], v[252:255]
    v_cmp_eq_u32 vcc, -1, v44
    v_mfma_f32_16x16x32_bf16 v[208:211], v[184:187], a[56:59], v[208:211]
    s_cbranch_vccnz L_r_gs8
L_r_gb8:
    s_barrier
    v_mfma_f32_16x16x32_bf16 v[212:215], v[184:187], a[60:63], v[212:215]
    ds_read_b128 v[176:179], v156 offset:36864
    ds_read_b128 v[180:183], v156 offset:37888
    v_mfma_f32_16x16x32_bf16 v[216:219], v[188:191], a[56:59], v[216:219]
    ds_read_b128 v[184:187], v156 offset:38912
    v_mfma_f32_16x16x32_bf16 v[220:223], v[188:191], a[60:63], v[220:223]
    ds_read_b128 v[188:191], v156 offset:39936
    s_waitcnt lgkmcnt(4)
    v_mfma_f32_16x16x32_bf16 v[224:227], v[192:195], a[56:59], v[224:227]
    v_mfma_f32_16x16x32_bf16 v[228:231], v[192:195], a[60:63], v[228:231]
    ds_read_b128 v[192:195], v156 offset:43008
    v_mfma_f32_16x16x32_bf16 v[232:235], v[196:199], a[56:59], v[232:235]
    v_mfma_f32_16x16x32_bf16 v[236:239], v[196:199], a[60:63], v[236:239]
    ds_read_b128 v[196:199], v156 offset:44032
    v_mfma_f32_16x16x32_bf16 v[240:243], v[200:203], a[56:59], v[240:243]
    v_mfma_f32_16x16x32_bf16 v[244:247], v[200:203], a[60:63], v[244:247]
    ds_read_b128 v[200:203], v156 offset:45056
    v_mfma_f32_16x16x32_bf16 v[248:251], v[204:207], a[56:59], v[248:251]
    v_mfma_f32_16x16x32_bf16 v[252:255], v[204:207], a[60:63], v[252:255]
    ds_read_b128 v[204:207], v156 offset:46080
    s_waitcnt lgkmcnt(4)
    s_waitcnt vmcnt(8)
    v_mfma_f32_16x16x32_bf16 v[208:211], v[176:179], a[64:67], v[208:211]
    v_mfma_f32_16x16x32_bf16 v[212:215], v[176:179], a[68:71], v[212:215]
    v_mfma_f32_16x16x32_bf16 v[216:219], v[180:183], a[64:67], v[216:219]
    v_mfma_f32_16x16x32_bf16 v[220:223], v[180:183], a[68:71], v[220:223]
    v_mfma_f32_16x16x32_bf16 v[224:227], v[184:187], a[64:67], v[224:227]
    v_mfma_f32_16x16x32_bf16 v[228:231], v[184:187], a[68:71], v[228:231]
    v_mfma_f32_16x16x32_bf16 v[232:235], v[188:191], a[64:67], v[232:235]
    s_waitcnt vmcnt(4)
    ds_read_b128 v[32:35], v158 offset:49152
    ds_read_b128 v[36:39], v158 offset:50176
    ds_read_b128 v[40:43], v158 offset:51200
    v_mfma_f32_16x16x32_bf16 v[236:239], v[188:191], a[68:71], v[236:239]
    s_waitcnt lgkmcnt(3)
    v_mfma_f32_16x16x32_bf16 v[208:211], v[192:195], a[72:75], v[208:211]
    v_mfma_f32_16x16x32_bf16 v[212:215], v[192:195], a[76:79], v[212:215]
    v_mfma_f32_16x16x32_bf16 v[216:219], v[196:199], a[72:75], v[216:219]
    v_mfma_f32_16x16x32_bf16 v[220:223], v[196:199], a[76:79], v[220:223]
    v_mfma_f32_16x16x32_bf16 v[224:227], v[200:203], a[72:75], v[224:227]
    v_mfma_f32_16x16x32_bf16 v[228:231], v[200:203], a[76:79], v[228:231]
    v_mfma_f32_16x16x32_bf16 v[232:235], v[204:207], a[72:75], v[232:235]
    v_mfma_f32_16x16x32_bf16 v[236:239], v[204:207], a[76:79], v[236:239]
    s_waitcnt lgkmcnt(0)
    v_max3_u32 v44, v32, v34, v36
    v_max3_u32 v38, v38, v40, v42
    v_max_u32 v44, v44, v38
    v_cmp_eq_u32 vcc, -1, v44
    s_cbranch_vccnz L_r_gs9
L_r_gb9:
    s_barrier
    ds_read_b128 v[176:179], v156 offset:49152
    ds_read_b128 v[180:183], v156 offset:50176
    ds_read_b128 v[184:187], v156 offset:51200
    ds_read_b128 v[188:191], v156 offset:52224
    ds_read_b128 v[192:195], v156 offset:55296
    ds_read_b128 v[196:199], v156 offset:56320
    ds_read_b128 v[200:203], v156 offset:57344
    ds_read_b128 v[204:207], v156 offset:58368
    s_waitcnt lgkmcnt(7)
    s_waitcnt vmcnt(2)
    v_mfma_f32_16x16x32_bf16 v[208:211], v[176:179], a[80:83], v[208:211]
    v_mfma_f32_16x16x32_bf16 v[212:215], v[176:179], a[84:87], v[212:215]
    ds_read_b128 v[176:179], v156 offset:40960
    s_waitcnt lgkmcnt(6)
    v_mfma_f32_16x16x32_bf16 v[216:219], v[180:183], a[80:83], v[216:219]
    v_mfma_f32_16x16x32_bf16 v[220:223], v[180:183], a[84:87], v[220:223]
    ds_read_b128 v[180:183], v156 offset:41984
    v_mfma_f32_16x16x32_bf16 v[224:227], v[184:187], a[80:83], v[224:227]
    v_mfma_f32_16x16x32_bf16 v[228:231], v[184:187], a[84:87], v[228:231]
    ds_read_b128 v[184:187], v156 offset:47104
    s_waitcnt lgkmcnt(4)
    v_mfma_f32_16x16x32_bf16 v[232:235], v[188:191], a[80:83], v[232:235]
    v_mfma_f32_16x16x32_bf16 v[236:239], v[188:191], a[84:87], v[236:239]
    ds_read_b128 v[188:191], v156 offset:48128
    s_waitcnt vmcnt(0)
    v_mfma_f32_16x16x32_bf16 v[208:211], v[192:195], a[88:91], v[208:211]
    v_mfma_f32_16x16x32_bf16 v[212:215], v[192:195], a[92:95], v[212:215]
    ds_read_b128 v[192:195], v156 offset:53248
    v_mfma_f32_16x16x32_bf16 v[216:219], v[196:199], a[88:91], v[216:219]
    v_cvt_pk_bf16_f32 v112, v208, v209
    v_cvt_pk_bf16_f32 v113, v210, v211
    v_mfma_f32_16x16x32_bf16 v[220:223], v[196:199], a[92:95], v[220:223]
    ds_read_b128 v[196:199], v156 offset:54272
    v_mfma_f32_16x16x32_bf16 v[224:227], v[200:203], a[88:91], v[224:227]
    v_cvt_pk_bf16_f32 v114, v216, v217
    v_cvt_pk_bf16_f32 v115, v218, v219
    s_nop 0
    v_permlane16_swap_b32 v112, v114
    v_permlane16_swap_b32 v113, v115
    buffer_store_dwordx4 v[112:115], v150, s[40:43], 0 offen offset:0 nt
    v_cvt_pk_bf16_f32 v116, v212, v213
    v_cvt_pk_bf16_f32 v117, v214, v215
    v_cvt_pk_bf16_f32 v118, v220, v221
    v_cvt_pk_bf16_f32 v119, v222, v223
    s_nop 0
    v_permlane16_swap_b32 v116, v118
    v_permlane16_swap_b32 v117, v119
    buffer_store_dwordx4 v[116:119], v151, s[40:43], 0 offen offset:0 nt
    v_cvt_pk_bf16_f32 v120, v224, v225
    v_cvt_pk_bf16_f32 v121, v226, v227
    v_mfma_f32_16x16x32_bf16 v[228:231], v[200:203], a[92:95], v[228:231]
    ds_read_b128 v[200:203], v156 offset:59392
    s_waitcnt lgkmcnt(2)
    v_mfma_f32_16x16x32_bf16 v[232:235], v[204:207], a[88:91], v[232:235]
    v_mfma_f32_16x16x32_bf16 v[236:239], v[204:207], a[92:95], v[236:239]
    ds_read_b128 v[204:207], v156 offset:60416
    v_mfma_f32_16x16x32_bf16 v[240:243], v[176:179], a[64:67], v[240:243]
    v_cvt_pk_bf16_f32 v122, v232, v233
    v_cvt_pk_bf16_f32 v123, v234, v235
    s_nop 0
    v_permlane16_swap_b32 v120, v122
    v_permlane16_swap_b32 v121, v123
    buffer_store_dwordx4 v[120:123], v150, s[40:43], 0 offen offset:64 nt
    v_cvt_pk_bf16_f32 v124, v228, v229
    v_cvt_pk_bf16_f32 v125, v230, v231
    v_cvt_pk_bf16_f32 v126, v236, v237
    v_cvt_pk_bf16_f32 v127, v238, v239
    s_nop 0
    v_permlane16_swap_b32 v124, v126
    v_permlane16_swap_b32 v125, v127
    buffer_store_dwordx4 v[124:127], v151, s[40:43], 0 offen offset:64 nt
    v_mfma_f32_16x16x32_bf16 v[244:247], v[176:179], a[68:71], v[244:247]
    v_mfma_f32_16x16x32_bf16 v[248:251], v[180:183], a[64:67], v[248:251]
    v_mfma_f32_16x16x32_bf16 v[252:255], v[180:183], a[68:71], v[252:255]
    v_mfma_f32_16x16x32_bf16 v[240:243], v[184:187], a[72:75], v[240:243]
    v_mfma_f32_16x16x32_bf16 v[244:247], v[184:187], a[76:79], v[244:247]
    v_mfma_f32_16x16x32_bf16 v[248:251], v[188:191], a[72:75], v[248:251]
    v_mfma_f32_16x16x32_bf16 v[252:255], v[188:191], a[76:79], v[252:255]
    v_mfma_f32_16x16x32_bf16 v[240:243], v[192:195], a[80:83], v[240:243]
    v_mfma_f32_16x16x32_bf16 v[244:247], v[192:195], a[84:87], v[244:247]
    s_waitcnt lgkmcnt(0)
    v_mfma_f32_16x16x32_bf16 v[248:251], v[196:199], a[80:83], v[248:251]
    v_mfma_f32_16x16x32_bf16 v[252:255], v[196:199], a[84:87], v[252:255]
    v_mfma_f32_16x16x32_bf16 v[240:243], v[200:203], a[88:91], v[240:243]
    v_mfma_f32_16x16x32_bf16 v[244:247], v[200:203], a[92:95], v[244:247]
    v_mfma_f32_16x16x32_bf16 v[248:251], v[204:207], a[88:91], v[248:251]
    v_cvt_pk_bf16_f32 v128, v240, v241
    v_cvt_pk_bf16_f32 v129, v242, v243
    v_mfma_f32_16x16x32_bf16 v[252:255], v[204:207], a[92:95], v[252:255]
    s_nop 3
    v_cvt_pk_bf16_f32 v130, v248, v249
    v_cvt_pk_bf16_f32 v131, v250, v251
    s_nop 0
    v_permlane16_swap_b32 v128, v130
    v_permlane16_swap_b32 v129, v131
    buffer_store_dwordx4 v[128:131], v150, s[40:43], 0 offen offset:128 nt
    v_cvt_pk_bf16_f32 v132, v244, v245
    v_cvt_pk_bf16_f32 v133, v246, v247
    v_cvt_pk_bf16_f32 v134, v252, v253
    v_cvt_pk_bf16_f32 v135, v254, v255
    s_nop 0
    v_permlane16_swap_b32 v132, v134
    v_permlane16_swap_b32 v133, v135
    buffer_store_dwordx4 v[132:135], v151, s[40:43], 0 offen offset:128 nt
    s_endpgm
L_r_sl1:
    s_mov_b32 s54, 0
L_r_sl1l:
    s_add_u32 s54, s54, 1
    s_cmp_gt_u32 s54, 30000
    s_cbranch_scc1 L_r_bk1
    global_load_dword v24, v25, s[18:19] sc1
    s_waitcnt vmcnt(0)
    v_cmp_ne_u32 vcc, 1, v24
    s_cmp_lg_u64 vcc, 0
    s_cbranch_scc1 L_r_sl1l
    s_branch L_r_bk1
L_r_sl2:
    s_mov_b32 s54, 0
L_r_sl2l:
    s_add_u32 s54, s54, 1
    s_cmp_gt_u32 s54, 30000
    s_cbranch_scc1 L_r_bk2
    buffer_load_dword v21, v1, s[36:39], s9 offen sc1
    s_waitcnt vmcnt(0)
    v_cmp_ne_u32 vcc, 1, v21
    s_cmp_lg_u64 vcc, 0
    s_cbranch_scc1 L_r_sl2l
    s_branch L_r_bk2
L_r_sl3:
    s_mov_b32 s54, 0
L_r_sl3l:
    s_add_u32 s54, s54, 1
    s_cmp_gt_u32 s54, 30000
    s_cbranch_scc1 L_r_bk3
    buffer_load_dword v22, v17, s[36:39], s14 offen sc1
    s_waitcnt vmcnt(0)
    v_cmp_ne_u32 vcc, 1, v22
    s_cmp_lg_u64 vcc, 0
    s_cbranch_scc1 L_r_sl3l
    s_branch L_r_bk3
L_r_gs0:
    s_mov_b32 s54, 0
    s_mov_b32 s52, m0
    s_add_u32 m0, s22, 0
L_r_gs0l:
    s_add_u32 s54, s54, 1
    s_cmp_gt_u32 s54, 30000
    s_cbranch_scc1 L_r_gs0x
    buffer_load_dwordx4 v152, s[36:39], s57 offen offset:0 sc1 lds
    buffer_load_dwordx4 v153, s[36:39], s57 offen offset:1024 sc1 lds
    buffer_load_dwordx4 v154, s[36:39], s57 offen offset:2048 sc1 lds
    s_waitcnt vmcnt(0)
    ds_read_b128 v[32:35], v157 offset:0
    ds_read_b128 v[36:39], v157 offset:1024
    ds_read_b128 v[40:43], v157 offset:2048
    s_waitcnt lgkmcnt(0)
    v_max3_u32 v44, v32, v34, v36
    v_max3_u32 v38, v38, v40, v42
    v_max_u32 v44, v44, v38
    v_cmp_eq_u32 vcc, -1, v44
    s_nop 1
    s_cbranch_vccnz L_r_gs0l
L_r_gs0x:
    s_mov_b32 m0, s52
    s_branch L_r_gb0
L_r_gs1:
    s_mov_b32 s54, 0
    s_mov_b32 s52, m0
    s_add_u32 m0, s22, 12288
L_r_gs1l:
    s_add_u32 s54, s54, 1
    s_cmp_gt_u32 s54, 30000
    s_cbranch_scc1 L_r_gs1x
    buffer_load_dwordx4 v152, s[36:39], s58 offen offset:0 sc1 lds
    buffer_load_dwordx4 v153, s[36:39], s58 offen offset:1024 sc1 lds
    buffer_load_dwordx4 v154, s[36:39], s58 offen offset:2048 sc1 lds
    s_waitcnt vmcnt(0)
    ds_read_b128 v[32:35], v157 offset:12288
    ds_read_b128 v[36:39], v157 offset:13312
    ds_read_b128 v[40:43], v157 offset:14336
    s_waitcnt lgkmcnt(0)
    v_max3_u32 v44, v32, v34, v36
    v_max3_u32 v38, v38, v40, v42
    v_max_u32 v44, v44, v38
    v_cmp_eq_u32 vcc, -1, v44
    s_nop 1
    s_cbranch_vccnz L_r_gs1l
L_r_gs1x:
    s_mov_b32 m0, s52
    s_branch L_r_gb1
L_r_gs2:
    s_mov_b32 s54, 0
    s_mov_b32 s52, m0
    s_add_u32 m0, s22, 24576
L_r_gs2l:
    s_add_u32 s54, s54, 1
    s_cmp_gt_u32 s54, 30000
    s_cbranch_scc1 L_r_gs2x
    buffer_load_dwordx4 v152, s[36:39], s59 offen offset:0 sc1 lds
    buffer_load_dwordx4 v153, s[36:39], s59 offen offset:1024 sc1 lds
    buffer_load_dwordx4 v154, s[36:39], s59 offen offset:2048 sc1 lds
    s_waitcnt vmcnt(0)
    ds_read_b128 v[32:35], v157 offset:24576
    ds_read_b128 v[36:39], v157 offset:25600
    ds_read_b128 v[40:43], v157 offset:26624
    s_waitcnt lgkmcnt(0)
    v_max3_u32 v44, v32, v34, v36
    v_max3_u32 v38, v38, v40, v42
    v_max_u32 v44, v44, v38
    v_cmp_eq_u32 vcc, -1, v44
    s_nop 1
    s_cbranch_vccnz L_r_gs2l
L_r_gs2x:
    s_mov_b32 m0, s52
    s_branch L_r_gb2
L_r_gs3:
    s_mov_b32 s54, 0
    s_mov_b32 s52, m0
    s_add_u32 m0, s22, 36864
L_r_gs3l:
    s_add_u32 s54, s54, 1
    s_cmp_gt_u32 s54, 30000
    s_cbranch_scc1 L_r_gs3x
    buffer_load_dwordx4 v152, s[36:39], s60 offen offset:0 sc1 lds
    buffer_load_dwordx4 v153, s[36:39], s60 offen offset:1024 sc1 lds
    buffer_load_dwordx4 v154, s[36:39], s60 offen offset:2048 sc1 lds
    s_waitcnt vmcnt(0)
    ds_read_b128 v[32:35], v157 offset:36864
    ds_read_b128 v[36:39], v157 offset:37888
    ds_read_b128 v[40:43], v157 offset:38912
    s_waitcnt lgkmcnt(0)
    v_max3_u32 v44, v32, v34, v36
    v_max3_u32 v38, v38, v40, v42
    v_max_u32 v44, v44, v38
    v_cmp_eq_u32 vcc, -1, v44
    s_nop 1
    s_cbranch_vccnz L_r_gs3l
L_r_gs3x:
    s_mov_b32 m0, s52
    s_branch L_r_gb3
L_r_gs4:
    s_mov_b32 s54, 0
    s_mov_b32 s52, m0
    s_add_u32 m0, s22, 49152
L_r_gs4l:
    s_add_u32 s54, s54, 1
    s_cmp_gt_u32 s54, 30000
    s_cbranch_scc1 L_r_gs4x
    buffer_load_dwordx4 v152, s[36:39], s61 offen offset:0 sc1 lds
    buffer_load_dwordx4 v153, s[36:39], s61 offen offset:1024 sc1 lds
    buffer_load_dwordx4 v154, s[36:39], s61 offen offset:2048 sc1 lds
    s_waitcnt vmcnt(0)
    ds_read_b128 v[32:35], v157 offset:49152
    ds_read_b128 v[36:39], v157 offset:50176
    ds_read_b128 v[40:43], v157 offset:51200
    s_waitcnt lgkmcnt(0)
    v_max3_u32 v44, v32, v34, v36
    v_max3_u32 v38, v38, v40, v42
    v_max_u32 v44, v44, v38
    v_cmp_eq_u32 vcc, -1, v44
    s_nop 1
    s_cbranch_vccnz L_r_gs4l
L_r_gs4x:
    s_mov_b32 m0, s52
    s_branch L_r_gb4
L_r_gs5:
    s_mov_b32 s54, 0
    s_mov_b32 s52, m0
    s_add_u32 m0, s22, 61440
L_r_gs5l:
    s_add_u32 s54, s54, 1
    s_cmp_gt_u32 s54, 30000
    s_cbranch_scc1 L_r_gs5x
    buffer_load_dwordx4 v152, s[36:39], s62 offen offset:0 sc1 lds
    buffer_load_dwordx4 v153, s[36:39], s62 offen offset:1024 sc1 lds
    buffer_load_dwordx4 v154, s[36:39], s62 offen offset:2048 sc1 lds
    s_waitcnt vmcnt(0)
    ds_read_b128 v[32:35], v158 offset:0
    ds_read_b128 v[36:39], v158 offset:1024
    ds_read_b128 v[40:43], v158 offset:2048
    s_waitcnt lgkmcnt(0)
    v_max3_u32 v44, v32, v34, v36
    v_max3_u32 v38, v38, v40, v42
    v_max_u32 v44, v44, v38
    v_cmp_eq_u32 vcc, -1, v44
    s_nop 1
    s_cbranch_vccnz L_r_gs5l
L_r_gs5x:
    s_mov_b32 m0, s52
    s_branch L_r_gb5
L_r_gs6:
    s_mov_b32 s54, 0
    s_mov_b32 s52, m0
    s_add_u32 m0, s22, 73728
L_r_gs6l:
    s_add_u32 s54, s54, 1
    s_cmp_gt_u32 s54, 30000
    s_cbranch_scc1 L_r_gs6x
    buffer_load_dwordx4 v152, s[36:39], s63 offen offset:0 sc1 lds
    buffer_load_dwordx4 v153, s[36:39], s63 offen offset:1024 sc1 lds
    buffer_load_dwordx4 v154, s[36:39], s63 offen offset:2048 sc1 lds
    s_waitcnt vmcnt(0)
    ds_read_b128 v[32:35], v158 offset:12288
    ds_read_b128 v[36:39], v158 offset:13312
    ds_read_b128 v[40:43], v158 offset:14336
    s_waitcnt lgkmcnt(0)
    v_max3_u32 v44, v32, v34, v36
    v_max3_u32 v38, v38, v40, v42
    v_max_u32 v44, v44, v38
    v_cmp_eq_u32 vcc, -1, v44
    s_nop 1
    s_cbranch_vccnz L_r_gs6l
L_r_gs6x:
    s_mov_b32 m0, s52
    s_branch L_r_gb6
L_r_gs7:
    s_mov_b32 s54, 0
    s_mov_b32 s52, m0
    s_add_u32 m0, s22, 86016
L_r_gs7l:
    s_add_u32 s54, s54, 1
    s_cmp_gt_u32 s54, 30000
    s_cbranch_scc1 L_r_gs7x
    buffer_load_dwordx4 v152, s[36:39], s64 offen offset:0 sc1 lds
    buffer_load_dwordx4 v153, s[36:39], s64 offen offset:1024 sc1 lds
    buffer_load_dwordx4 v154, s[36:39], s64 offen offset:2048 sc1 lds
    s_waitcnt vmcnt(0)
    ds_read_b128 v[32:35], v158 offset:24576
    ds_read_b128 v[36:39], v158 offset:25600
    ds_read_b128 v[40:43], v158 offset:26624
    s_waitcnt lgkmcnt(0)
    v_max3_u32 v44, v32, v34, v36
    v_max3_u32 v38, v38, v40, v42
    v_max_u32 v44, v44, v38
    v_cmp_eq_u32 vcc, -1, v44
    s_nop 1
    s_cbranch_vccnz L_r_gs7l
L_r_gs7x:
    s_mov_b32 m0, s52
    s_branch L_r_gb7
L_r_gs8:
    s_mov_b32 s54, 0
    s_mov_b32 s52, m0
    s_add_u32 m0, s22, 98304
L_r_gs8l:
    s_add_u32 s54, s54, 1
    s_cmp_gt_u32 s54, 30000
    s_cbranch_scc1 L_r_gs8x
    buffer_load_dwordx4 v152, s[36:39], s65 offen offset:0 sc1 lds
    buffer_load_dwordx4 v153, s[36:39], s65 offen offset:1024 sc1 lds
    buffer_load_dwordx4 v154, s[36:39], s65 offen offset:2048 sc1 lds
    s_waitcnt vmcnt(0)
    ds_read_b128 v[32:35], v158 offset:36864
    ds_read_b128 v[36:39], v158 offset:37888
    ds_read_b128 v[40:43], v158 offset:38912
    s_waitcnt lgkmcnt(0)
    v_max3_u32 v44, v32, v34, v36
    v_max3_u32 v38, v38, v40, v42
    v_max_u32 v44, v44, v38
    v_cmp_eq_u32 vcc, -1, v44
    s_nop 1
    s_cbranch_vccnz L_r_gs8l
L_r_gs8x:
    s_mov_b32 m0, s52
    s_branch L_r_gb8
L_r_gs9:
    s_mov_b32 s54, 0
    s_mov_b32 s52, m0
    s_add_u32 m0, s22, 110592
L_r_gs9l:
    s_add_u32 s54, s54, 1
    s_cmp_gt_u32 s54, 30000
    s_cbranch_scc1 L_r_gs9x
    buffer_load_dwordx4 v152, s[36:39], s66 offen offset:0 sc1 lds
    buffer_load_dwordx4 v153, s[36:39], s66 offen offset:1024 sc1 lds
    buffer_load_dwordx4 v154, s[36:39], s66 offen offset:2048 sc1 lds
    s_waitcnt vmcnt(0)
    ds_read_b128 v[32:35], v158 offset:49152
    ds_read_b128 v[36:39], v158 offset:50176
    ds_read_b128 v[40:43], v158 offset:51200
    s_waitcnt lgkmcnt(0)
    v_max3_u32 v44, v32, v34, v36
    v_max3_u32 v38, v38, v40, v42
    v_max_u32 v44, v44, v38
    v_cmp_eq_u32 vcc, -1, v44
    s_nop 1
    s_cbranch_vccnz L_r_gs9l
L_r_gs9x:
    s_mov_b32 m0, s52
    s_branch L_r_gb9
L_xbody:
    s_mov_b32 s28, s12
    s_and_b32 s29, s13, 0xffff
    s_mov_b32 s36, s20
    s_and_b32 s37, s21, 0xffff
    s_lshr_b32 s59, s57, 2
    s_lshl_b32 s64, s23, 1
    s_add_u32 s59, s59, s64
    s_lshl_b32 s64, s62, 2
    s_add_u32 s64, s64, s3
    s_mul_i32 s78, s64, 20480
    s_mul_i32 s65, s59, 320
    s_add_u32 s78, s78, s65
    v_lshrrev_b32 v0, 2, v1
    v_mul_u32_u24 v0, 205, v0
    v_xor_b32 v7, 32, v4
    s_movk_i32 s64, 960
    v_lshrrev_b32 v236, 10, v0
    v_mad_u32_u24 v236, v236, s64, v4
    v_add_u32 v237, 3280, v0
    v_lshrrev_b32 v237, 10, v237
    v_mad_u32_u24 v237, v237, s64, v4
    v_add_u32 v238, 6560, v0
    v_lshrrev_b32 v238, 10, v238
    v_and_b32 v6, 8, v238
    v_lshlrev_b32 v6, 2, v6
    v_xor_b32 v6, v6, v4
    v_mad_u32_u24 v238, v238, s64, v6
    v_add_u32 v239, 9840, v0
    v_lshrrev_b32 v239, 10, v239
    v_mad_u32_u24 v239, v239, s64, v7
    v_add_u32 v240, 13120, v0
    v_lshrrev_b32 v240, 10, v240
    v_add_u32 v7, 4096, v7
    v_mad_u32_u24 v240, v240, s64, v7
    s_add_u32 m0, s92, 4096
    s_nop 0
    buffer_load_dwordx4 v236, s[28:31], s78 offen offset:0 lds
    buffer_load_dwordx4 v237, s[28:31], s78 offen offset:1024 lds
    buffer_load_dwordx4 v238, s[28:31], s78 offen offset:2048 lds
    buffer_load_dwordx4 v239, s[28:31], s78 offen offset:3072 lds
    s_add_u32 m0, s92, 8192
    s_nop 0
    buffer_load_dwordx4 v240, s[28:31], s78 offen offset:0 lds
    s_add_u32 m0, s92, 36864
    s_add_u32 s76, s76, 128
    s_cmp_ge_u32 s76, s77
    s_cselect_b32 s55, 1280, 0
    s_sub_u32 s76, s76, s55
    buffer_load_dwordx4 v232, s[24:27], s76 offen offset:0 lds
    s_lshr_b32 s60, s3, 1
    s_and_b32 s61, s3, 1
    v_and_b32 v0, 7, v3
    v_xor_b32 v0, v0, v2
    v_lshlrev_b32 v0, 4, v0
    v_lshl_add_u32 v0, v3, 7, v0
    s_mul_i32 s64, s60, 18432
    v_add_u32 v241, s64, v0
    v_xor_b32 v242, 64, v241
    v_add_u32 v243, 73728, v241
    v_add_u32 v244, 73728, v242
    v_and_b32 v6, 1, v2
    v_lshrrev_b32 v0, 2, v3
    v_lshl_add_u32 v0, v6, 3, v0
    v_mul_u32_u24 v0, 320, v0
    v_lshrrev_b32 v7, 1, v2
    v_lshlrev_b32 v249, 9, v7
    v_mul_u32_u24 v7, 9216, v7
    v_add_u32 v0, v0, v7
    v_and_b32 v7, 3, v3
    v_lshl_add_u32 v0, v7, 3, v0
    s_mul_i32 s64, s61, 5
    s_add_u32 s65, s64, 1
    v_xor_b32 v7, s64, v6
    v_lshl_add_u32 v245, v7, 5, v0
    v_add_u32 v247, 73728, v245
    v_xor_b32 v7, s65, v6
    v_lshl_add_u32 v246, v7, 5, v0
    v_add_u32 v248, 73728, v246
    v_lshl_add_u32 v249, v3, 4, v249
    v_mul_u32_u24 v6, 20480, v6
    v_add_u32 v249, v249, v6
    v_add_u32 v250, 40960, v249
    s_mov_b32 s40, s16
    s_and_b32 s41, s17, 0xffff
    s_mov_b32 s42, 6291456
    s_mov_b32 s43, 0x00020000
    s_and_b32 s64, s56, 3
    s_lshl_b32 s6, s22, 2
    s_add_u32 s6, s6, s64
    s_lshr_b32 s65, s56, 2
    s_lshl_b32 s7, s23, 3
    s_add_u32 s7, s7, s65
    s_lshr_b32 s14, s3, 1
    s_lshl1_add_u32 s14, s6, s14
    s_lshl_b32 s14, s14, 10
    s_add_u32 s14, s14, 178298880
    s_mov_b32 s13, 178331648
    s_mul_i32 s68, s64, 1
    s_add_u32 s68, s68, s65
    s_mov_b32 s54, 0x46814688
    s_bitcmp1_b32 s68, 2
    s_cselect_b32 s54, 0x46814688, s54
    s_lshl_b32 s69, s68, 4
    s_and_b32 s69, s69, 16
    s_lshr_b32 s12, s54, s69
    s_bitcmp1_b32 s68, 1
    s_cselect_b32 s16, 10240, 0
    s_sub_u32 s17, 10240, s16
    v_and_b32 v17, 7, v3
    v_lshlrev_b32 v17, 7, v17
    s_and_b32 s65, s3, 1
    s_lshl1_add_u32 s64, s7, s65
    s_mul_i32 s64, s64, 12
    v_min_u32 v19, 11, v3
    v_add_u32 v19, s64, v19
    v_lshlrev_b32 v19, 7, v19
    v_lshlrev_b32 v25, 2, v3
    s_lshl_b32 s54, s6, 3
    s_lshl_b32 s55, s3, 1
    s_add_u32 s54, s54, s55
    s_mul_i32 s55, s54, 20480
    s_add_u32 s55, s55, 167772160
    v_add_u32 v5, s55, v4
    v_add_u32 v6, 20480, v5
    s_lshl_b32 s54, s54, 4
    v_add_u32 v7, s54, v3
    v_mul_u32_u24 v7, 3072, v7
    v_and_b32 v8, 1, v2
    v_lshl_add_u32 v7, v8, 5, v7
    v_lshlrev_b32 v12, 9, v8
    v_lshrrev_b32 v8, 1, v2
    v_lshl_add_u32 v7, v8, 4, v7
    v_lshl_add_u32 v12, v8, 8, v12
    v_lshl_add_u32 v12, v3, 4, v12
    s_mul_i32 s54, s7, 192
    v_add_u32 v7, s54, v7
    v_add_u32 v8, 49152, v7
    s_and_b32 s54, s3, 1
    s_mul_i32 s54, s54, 3
    s_mul_i32 s55, s7, 6
    s_add_u32 s54, s54, s55
    s_mul_i32 s54, s54, 20480
    s_lshr_b32 s55, s3, 1
    s_lshl_b32 s55, s55, 10
    s_add_u32 s54, s54, s55
    s_add_u32 s54, s54, 170917888
    v_add_u32 v9, s54, v4
    v_add_u32 v10, 19456, v9
    v_add_u32 v11, 38912, v9
    v_add_u32 v0, 61440, v12
    s_mul_i32 s22, s3, 3072
    v_add_u32 v13, s22, v4
    v_add_u32 v14, 61440, v13
    s_lshl_b32 s64, s67, 1
    s_add_u32 s64, s64, s60
    s_mul_i32 s8, s64, 81920
    s_mul_i32 s64, s59, 5120
    s_add_u32 s8, s8, s64
    s_mul_i32 s64, s61, 2304
    s_add_u32 s8, s8, s64
    s_add_u32 s8, s8, 167772160
    s_lshl_b32 s64, s61, 9
    s_add_u32 s9, s8, s64
    s_add_u32 s9, s9, 256
    s_lshl1_add_u32 s64, s67, s60
    s_lshl2_add_u32 s64, s64, s59
    s_lshl1_add_u32 s64, s64, s61
    s_lshl_b32 s10, s64, 7
    s_add_u32 s10, s10, 178298880
    s_bfe_u32 s55, s12, 0x30000
    s_lshl_b32 s55, s55, 11
    s_add_u32 s57, s55, s16
    s_add_u32 s58, s55, s17
    s_bfe_u32 s55, s12, 0x30003
    s_lshl_b32 s55, s55, 11
    s_add_u32 s59, s55, s16
    s_add_u32 s60, s55, s17
    s_bfe_u32 s55, s12, 0x30006
    s_lshl_b32 s55, s55, 11
    s_add_u32 s61, s55, s16
    s_add_u32 s62, s55, s17
    s_bfe_u32 s55, s12, 0x30009
    s_lshl_b32 s55, s55, 11
    s_add_u32 s63, s55, s16
    s_add_u32 s64, s55, s17
    s_bfe_u32 s55, s12, 0x3000c
    s_lshl_b32 s55, s55, 11
    s_add_u32 s65, s55, s16
    s_add_u32 s66, s55, s17
    buffer_load_dwordx4 v233, s[24:27], s76 offen offset:1024 lds
    buffer_load_dwordx4 v234, s[24:27], s76 offen offset:2048 lds
    buffer_load_dwordx4 v235, s[24:27], s76 offen offset:3072 lds
    s_add_u32 m0, s92, 40960
    s_add_u32 s78, s78, 81920
    s_cmp_ge_u32 s78, 819200
    s_cselect_b32 s55, 819200, 0
    s_sub_u32 s78, s78, s55
    buffer_load_dwordx4 v236, s[28:31], s78 offen offset:0 lds
    buffer_load_dwordx4 v237, s[28:31], s78 offen offset:1024 lds
    buffer_load_dwordx4 v238, s[28:31], s78 offen offset:2048 lds
    buffer_load_dwordx4 v239, s[28:31], s78 offen offset:3072 lds
    s_add_u32 m0, s92, 45056
    s_nop 0
    buffer_load_dwordx4 v240, s[28:31], s78 offen offset:0 lds
    s_add_u32 m0, s92, 73728
    s_add_u32 s76, s76, 128
    s_cmp_ge_u32 s76, s77
    s_cselect_b32 s55, 1280, 0
    s_sub_u32 s76, s76, s55
    buffer_load_dwordx4 v232, s[24:27], s76 offen offset:0 lds
    s_waitcnt vmcnt(10)
    s_barrier
    ds_read_b128 v[112:115], v241 offset:0
    ds_read_b64_tr_b16 v[128:129], v245 offset:4096
    ds_read_b64_tr_b16 v[130:131], v245 offset:5376
    ds_read_b128 v[116:119], v241 offset:2048
    ds_read_b64_tr_b16 v[132:133], v246 offset:4096
    ds_read_b64_tr_b16 v[134:135], v246 offset:5376
    ds_read_b128 v[120:123], v241 offset:9216
    ds_read_b64_tr_b16 v[136:137], v245 offset:4160
    ds_read_b64_tr_b16 v[138:139], v245 offset:5440
    buffer_load_dwordx4 v233, s[24:27], s76 offen offset:1024 lds
    ds_read_b128 v[124:127], v241 offset:11264
    ds_read_b64_tr_b16 v[140:141], v246 offset:4160
    ds_read_b64_tr_b16 v[142:143], v246 offset:5440
    ds_read_b64_tr_b16 v[144:145], v245 offset:4224
    ds_read_b64_tr_b16 v[146:147], v245 offset:5504
    buffer_load_dwordx4 v234, s[24:27], s76 offen offset:2048 lds
    buffer_load_dwordx4 v235, s[24:27], s76 offen offset:3072 lds
    s_add_u32 m0, s92, 77824
    s_add_u32 s78, s78, 81920
    s_cmp_ge_u32 s78, 819200
    s_cselect_b32 s55, 819200, 0
    s_sub_u32 s78, s78, s55
    buffer_load_dwordx4 v236, s[28:31], s78 offen offset:0 lds
    s_waitcnt lgkmcnt(4)
    v_mfma_f32_16x16x32_bf16 v[32:35], v[128:131], v[112:115], 0
    ds_read_b128 v[148:151], v242 offset:0
    ds_read_b64_tr_b16 v[164:165], v245 offset:22528
    v_mfma_f32_16x16x32_bf16 v[36:39], v[128:131], v[116:119], 0
    ds_read_b64_tr_b16 v[166:167], v245 offset:23808
    ds_read_b128 v[152:155], v242 offset:2048
    v_mfma_f32_16x16x32_bf16 v[40:43], v[128:131], v[120:123], 0
    ds_read_b64_tr_b16 v[168:169], v246 offset:22528
    ds_read_b64_tr_b16 v[170:171], v246 offset:23808
    v_mfma_f32_16x16x32_bf16 v[44:47], v[128:131], v[124:127], 0
    buffer_load_dwordx4 v237, s[28:31], s78 offen offset:1024 lds
    v_mfma_f32_16x16x32_bf16 v[48:51], v[132:135], v[112:115], 0
    ds_read_b128 v[156:159], v242 offset:9216
    ds_read_b64_tr_b16 v[172:173], v245 offset:22592
    v_mfma_f32_16x16x32_bf16 v[52:55], v[132:135], v[116:119], 0
    ds_read_b64_tr_b16 v[174:175], v245 offset:23872
    buffer_load_dwordx4 v238, s[28:31], s78 offen offset:2048 lds
    v_mfma_f32_16x16x32_bf16 v[56:59], v[132:135], v[120:123], 0
    v_mfma_f32_16x16x32_bf16 v[60:63], v[132:135], v[124:127], 0
    v_mfma_f32_16x16x32_bf16 v[64:67], v[136:139], v[112:115], 0
    ds_read_b128 v[160:163], v242 offset:11264
    ds_read_b64_tr_b16 v[176:177], v246 offset:22592
    v_mfma_f32_16x16x32_bf16 v[68:71], v[136:139], v[116:119], 0
    s_waitcnt lgkmcnt(14)
    ds_read_b64_tr_b16 v[178:179], v246 offset:23872
    v_mfma_f32_16x16x32_bf16 v[72:75], v[136:139], v[120:123], 0
    s_waitcnt lgkmcnt(14)
    ds_read_b64_tr_b16 v[180:181], v245 offset:22656
    v_mfma_f32_16x16x32_bf16 v[76:79], v[136:139], v[124:127], 0
    s_waitcnt lgkmcnt(14)
    ds_read_b64_tr_b16 v[182:183], v245 offset:23936
    buffer_load_dwordx4 v239, s[28:31], s78 offen offset:3072 lds
    v_mfma_f32_16x16x32_bf16 v[80:83], v[140:143], v[112:115], 0
    s_add_u32 m0, s92, 81920
    s_nop 0
    v_mfma_f32_16x16x32_bf16 v[84:87], v[140:143], v[116:119], 0
    buffer_load_dwordx4 v240, s[28:31], s78 offen offset:0 lds
    s_waitcnt lgkmcnt(14)
    v_mfma_f32_16x16x32_bf16 v[88:91], v[140:143], v[120:123], 0
    v_mfma_f32_16x16x32_bf16 v[92:95], v[140:143], v[124:127], 0
    v_mfma_f32_16x16x32_bf16 v[96:99], v[144:147], v[112:115], 0
    s_add_u32 m0, s92, 110592
    s_add_u32 s76, s76, 128
    v_mfma_f32_16x16x32_bf16 v[100:103], v[144:147], v[116:119], 0
    s_cmp_ge_u32 s76, s77
    s_cselect_b32 s55, 1280, 0
    v_mfma_f32_16x16x32_bf16 v[104:107], v[144:147], v[120:123], 0
    s_sub_u32 s76, s76, s55
    buffer_load_dwordx4 v232, s[24:27], s76 offen offset:0 lds
    v_mfma_f32_16x16x32_bf16 v[108:111], v[144:147], v[124:127], 0
    s_waitcnt vmcnt(10)
    s_waitcnt lgkmcnt(0)
    s_barrier
    v_mfma_f32_16x16x32_bf16 v[32:35], v[164:167], v[148:151], v[32:35]
    ds_read_b128 v[112:115], v241 offset:36864
    ds_read_b64_tr_b16 v[128:129], v245 offset:40960
    v_mfma_f32_16x16x32_bf16 v[36:39], v[164:167], v[152:155], v[36:39]
    ds_read_b64_tr_b16 v[130:131], v245 offset:42240
    ds_read_b128 v[116:119], v241 offset:38912
    v_mfma_f32_16x16x32_bf16 v[40:43], v[164:167], v[156:159], v[40:43]
    ds_read_b64_tr_b16 v[132:133], v246 offset:40960
    ds_read_b64_tr_b16 v[134:135], v246 offset:42240
    v_mfma_f32_16x16x32_bf16 v[44:47], v[164:167], v[160:163], v[44:47]
    v_mfma_f32_16x16x32_bf16 v[48:51], v[168:171], v[148:151], v[48:51]
    ds_read_b128 v[120:123], v241 offset:46080
    ds_read_b64_tr_b16 v[136:137], v245 offset:41024
    v_mfma_f32_16x16x32_bf16 v[52:55], v[168:171], v[152:155], v[52:55]
    ds_read_b64_tr_b16 v[138:139], v245 offset:42304
    buffer_load_dwordx4 v233, s[24:27], s76 offen offset:1024 lds
    v_mfma_f32_16x16x32_bf16 v[56:59], v[168:171], v[156:159], v[56:59]
    v_mfma_f32_16x16x32_bf16 v[60:63], v[168:171], v[160:163], v[60:63]
    v_mfma_f32_16x16x32_bf16 v[64:67], v[172:175], v[148:151], v[64:67]
    ds_read_b128 v[124:127], v241 offset:48128
    ds_read_b64_tr_b16 v[140:141], v246 offset:41024
    v_mfma_f32_16x16x32_bf16 v[68:71], v[172:175], v[152:155], v[68:71]
    ds_read_b64_tr_b16 v[142:143], v246 offset:42304
    ds_read_b64_tr_b16 v[144:145], v245 offset:41088
    v_mfma_f32_16x16x32_bf16 v[72:75], v[172:175], v[156:159], v[72:75]
    ds_read_b64_tr_b16 v[146:147], v245 offset:42368
    buffer_load_dwordx4 v234, s[24:27], s76 offen offset:2048 lds
    v_mfma_f32_16x16x32_bf16 v[76:79], v[172:175], v[160:163], v[76:79]
    v_mfma_f32_16x16x32_bf16 v[80:83], v[176:179], v[148:151], v[80:83]
    buffer_load_dwordx4 v235, s[24:27], s76 offen offset:3072 lds
    v_mfma_f32_16x16x32_bf16 v[84:87], v[176:179], v[152:155], v[84:87]
    v_mfma_f32_16x16x32_bf16 v[88:91], v[176:179], v[156:159], v[88:91]
    v_mfma_f32_16x16x32_bf16 v[92:95], v[176:179], v[160:163], v[92:95]
    v_mfma_f32_16x16x32_bf16 v[96:99], v[180:183], v[148:151], v[96:99]
    s_add_u32 m0, s92, 114688
    s_add_u32 s78, s78, 81920
    v_mfma_f32_16x16x32_bf16 v[100:103], v[180:183], v[152:155], v[100:103]
    s_cmp_ge_u32 s78, 819200
    s_cselect_b32 s55, 819200, 0
    v_mfma_f32_16x16x32_bf16 v[104:107], v[180:183], v[156:159], v[104:107]
    s_sub_u32 s78, s78, s55
    buffer_load_dwordx4 v236, s[28:31], s78 offen offset:0 lds
    v_mfma_f32_16x16x32_bf16 v[108:111], v[180:183], v[160:163], v[108:111]
    s_waitcnt lgkmcnt(4)
    v_mfma_f32_16x16x32_bf16 v[32:35], v[128:131], v[112:115], v[32:35]
    ds_read_b128 v[148:151], v242 offset:36864
    ds_read_b64_tr_b16 v[164:165], v245 offset:59392
    v_mfma_f32_16x16x32_bf16 v[36:39], v[128:131], v[116:119], v[36:39]
    ds_read_b64_tr_b16 v[166:167], v245 offset:60672
    ds_read_b128 v[152:155], v242 offset:38912
    v_mfma_f32_16x16x32_bf16 v[40:43], v[128:131], v[120:123], v[40:43]
    ds_read_b64_tr_b16 v[168:169], v246 offset:59392
    ds_read_b64_tr_b16 v[170:171], v246 offset:60672
    v_mfma_f32_16x16x32_bf16 v[44:47], v[128:131], v[124:127], v[44:47]
    buffer_load_dwordx4 v237, s[28:31], s78 offen offset:1024 lds
    v_mfma_f32_16x16x32_bf16 v[48:51], v[132:135], v[112:115], v[48:51]
    ds_read_b128 v[156:159], v242 offset:46080
    ds_read_b64_tr_b16 v[172:173], v245 offset:59456
    v_mfma_f32_16x16x32_bf16 v[52:55], v[132:135], v[116:119], v[52:55]
    ds_read_b64_tr_b16 v[174:175], v245 offset:60736
    buffer_load_dwordx4 v238, s[28:31], s78 offen offset:2048 lds
    v_mfma_f32_16x16x32_bf16 v[56:59], v[132:135], v[120:123], v[56:59]
    v_mfma_f32_16x16x32_bf16 v[60:63], v[132:135], v[124:127], v[60:63]
    v_mfma_f32_16x16x32_bf16 v[64:67], v[136:139], v[112:115], v[64:67]
    ds_read_b128 v[160:163], v242 offset:48128
    ds_read_b64_tr_b16 v[176:177], v246 offset:59456
    v_mfma_f32_16x16x32_bf16 v[68:71], v[136:139], v[116:119], v[68:71]
    s_waitcnt lgkmcnt(14)
    ds_read_b64_tr_b16 v[178:179], v246 offset:60736
    v_mfma_f32_16x16x32_bf16 v[72:75], v[136:139], v[120:123], v[72:75]
    s_waitcnt lgkmcnt(14)
    ds_read_b64_tr_b16 v[180:181], v245 offset:59520
    v_mfma_f32_16x16x32_bf16 v[76:79], v[136:139], v[124:127], v[76:79]
    s_waitcnt lgkmcnt(14)
    ds_read_b64_tr_b16 v[182:183], v245 offset:60800
    buffer_load_dwordx4 v239, s[28:31], s78 offen offset:3072 lds
    v_mfma_f32_16x16x32_bf16 v[80:83], v[140:143], v[112:115], v[80:83]
    s_add_u32 m0, s92, 118784
    s_nop 0
    v_mfma_f32_16x16x32_bf16 v[84:87], v[140:143], v[116:119], v[84:87]
    buffer_load_dwordx4 v240, s[28:31], s78 offen offset:0 lds
    s_waitcnt lgkmcnt(14)
    v_mfma_f32_16x16x32_bf16 v[88:91], v[140:143], v[120:123], v[88:91]
    v_mfma_f32_16x16x32_bf16 v[92:95], v[140:143], v[124:127], v[92:95]
    v_mfma_f32_16x16x32_bf16 v[96:99], v[144:147], v[112:115], v[96:99]
    s_add_u32 m0, s92, 0
    s_add_u32 s76, s76, 128
    v_mfma_f32_16x16x32_bf16 v[100:103], v[144:147], v[116:119], v[100:103]
    s_cmp_ge_u32 s76, s77
    s_cselect_b32 s55, 1280, 0
    v_mfma_f32_16x16x32_bf16 v[104:107], v[144:147], v[120:123], v[104:107]
    s_sub_u32 s76, s76, s55
    buffer_load_dwordx4 v232, s[24:27], s76 offen offset:0 lds
    v_mfma_f32_16x16x32_bf16 v[108:111], v[144:147], v[124:127], v[108:111]
    s_waitcnt vmcnt(10)
    s_waitcnt lgkmcnt(0)
    s_barrier
    v_mfma_f32_16x16x32_bf16 v[32:35], v[164:167], v[148:151], v[32:35]
    ds_read_b128 v[112:115], v243 offset:0
    ds_read_b64_tr_b16 v[128:129], v247 offset:4096
    v_mfma_f32_16x16x32_bf16 v[36:39], v[164:167], v[152:155], v[36:39]
    ds_read_b64_tr_b16 v[130:131], v247 offset:5376
    ds_read_b128 v[116:119], v243 offset:2048
    v_mfma_f32_16x16x32_bf16 v[40:43], v[164:167], v[156:159], v[40:43]
    ds_read_b64_tr_b16 v[132:133], v248 offset:4096
    ds_read_b64_tr_b16 v[134:135], v248 offset:5376
    v_mfma_f32_16x16x32_bf16 v[44:47], v[164:167], v[160:163], v[44:47]
    v_mfma_f32_16x16x32_bf16 v[48:51], v[168:171], v[148:151], v[48:51]
    ds_read_b128 v[120:123], v243 offset:9216
    ds_read_b64_tr_b16 v[136:137], v247 offset:4160
    v_mfma_f32_16x16x32_bf16 v[52:55], v[168:171], v[152:155], v[52:55]
    ds_read_b64_tr_b16 v[138:139], v247 offset:5440
    buffer_load_dwordx4 v233, s[24:27], s76 offen offset:1024 lds
    v_mfma_f32_16x16x32_bf16 v[56:59], v[168:171], v[156:159], v[56:59]
    v_mfma_f32_16x16x32_bf16 v[60:63], v[168:171], v[160:163], v[60:63]
    v_mfma_f32_16x16x32_bf16 v[64:67], v[172:175], v[148:151], v[64:67]
    ds_read_b128 v[124:127], v243 offset:11264
    ds_read_b64_tr_b16 v[140:141], v248 offset:4160
    v_mfma_f32_16x16x32_bf16 v[68:71], v[172:175], v[152:155], v[68:71]
    ds_read_b64_tr_b16 v[142:143], v248 offset:5440
    ds_read_b64_tr_b16 v[144:145], v247 offset:4224
    v_mfma_f32_16x16x32_bf16 v[72:75], v[172:175], v[156:159], v[72:75]
    ds_read_b64_tr_b16 v[146:147], v247 offset:5504
    buffer_load_dwordx4 v234, s[24:27], s76 offen offset:2048 lds
    v_mfma_f32_16x16x32_bf16 v[76:79], v[172:175], v[160:163], v[76:79]
    v_mfma_f32_16x16x32_bf16 v[80:83], v[176:179], v[148:151], v[80:83]
    buffer_load_dwordx4 v235, s[24:27], s76 offen offset:3072 lds
    v_mfma_f32_16x16x32_bf16 v[84:87], v[176:179], v[152:155], v[84:87]
    v_mfma_f32_16x16x32_bf16 v[88:91], v[176:179], v[156:159], v[88:91]
    v_mfma_f32_16x16x32_bf16 v[92:95], v[176:179], v[160:163], v[92:95]
    v_mfma_f32_16x16x32_bf16 v[96:99], v[180:183], v[148:151], v[96:99]
    s_add_u32 m0, s92, 4096
    s_add_u32 s78, s78, 81920
    v_mfma_f32_16x16x32_bf16 v[100:103], v[180:183], v[152:155], v[100:103]
    s_cmp_ge_u32 s78, 819200
    s_cselect_b32 s55, 819200, 0
    v_mfma_f32_16x16x32_bf16 v[104:107], v[180:183], v[156:159], v[104:107]
    s_sub_u32 s78, s78, s55
    buffer_load_dwordx4 v236, s[28:31], s78 offen offset:0 lds
    v_mfma_f32_16x16x32_bf16 v[108:111], v[180:183], v[160:163], v[108:111]
    s_waitcnt lgkmcnt(4)
    v_mfma_f32_16x16x32_bf16 v[32:35], v[128:131], v[112:115], v[32:35]
    ds_read_b128 v[148:151], v244 offset:0
    ds_read_b64_tr_b16 v[164:165], v247 offset:22528
    v_mfma_f32_16x16x32_bf16 v[36:39], v[128:131], v[116:119], v[36:39]
    ds_read_b64_tr_b16 v[166:167], v247 offset:23808
    ds_read_b128 v[152:155], v244 offset:2048
    v_mfma_f32_16x16x32_bf16 v[40:43], v[128:131], v[120:123], v[40:43]
    ds_read_b64_tr_b16 v[168:169], v248 offset:22528
    ds_read_b64_tr_b16 v[170:171], v248 offset:23808
    v_mfma_f32_16x16x32_bf16 v[44:47], v[128:131], v[124:127], v[44:47]
    buffer_load_dwordx4 v237, s[28:31], s78 offen offset:1024 lds
    v_mfma_f32_16x16x32_bf16 v[48:51], v[132:135], v[112:115], v[48:51]
    ds_read_b128 v[156:159], v244 offset:9216
    ds_read_b64_tr_b16 v[172:173], v247 offset:22592
    v_mfma_f32_16x16x32_bf16 v[52:55], v[132:135], v[116:119], v[52:55]
    ds_read_b64_tr_b16 v[174:175], v247 offset:23872
    buffer_load_dwordx4 v238, s[28:31], s78 offen offset:2048 lds
    v_mfma_f32_16x16x32_bf16 v[56:59], v[132:135], v[120:123], v[56:59]
    v_mfma_f32_16x16x32_bf16 v[60:63], v[132:135], v[124:127], v[60:63]
    v_mfma_f32_16x16x32_bf16 v[64:67], v[136:139], v[112:115], v[64:67]
    ds_read_b128 v[160:163], v244 offset:11264
    ds_read_b64_tr_b16 v[176:177], v248 offset:22592
    v_mfma_f32_16x16x32_bf16 v[68:71], v[136:139], v[116:119], v[68:71]
    s_waitcnt lgkmcnt(14)
    ds_read_b64_tr_b16 v[178:179], v248 offset:23872
    v_mfma_f32_16x16x32_bf16 v[72:75], v[136:139], v[120:123], v[72:75]
    s_waitcnt lgkmcnt(14)
    ds_read_b64_tr_b16 v[180:181], v247 offset:22656
    v_mfma_f32_16x16x32_bf16 v[76:79], v[136:139], v[124:127], v[76:79]
    s_waitcnt lgkmcnt(14)
    ds_read_b64_tr_b16 v[182:183], v247 offset:23936
    buffer_load_dwordx4 v239, s[28:31], s78 offen offset:3072 lds
    v_mfma_f32_16x16x32_bf16 v[80:83], v[140:143], v[112:115], v[80:83]
    s_add_u32 m0, s92, 8192
    s_nop 0
    v_mfma_f32_16x16x32_bf16 v[84:87], v[140:143], v[116:119], v[84:87]
    buffer_load_dwordx4 v240, s[28:31], s78 offen offset:0 lds
    s_waitcnt lgkmcnt(14)
    v_mfma_f32_16x16x32_bf16 v[88:91], v[140:143], v[120:123], v[88:91]
    v_mfma_f32_16x16x32_bf16 v[92:95], v[140:143], v[124:127], v[92:95]
    v_mfma_f32_16x16x32_bf16 v[96:99], v[144:147], v[112:115], v[96:99]
    s_add_u32 m0, s92, 36864
    s_add_u32 s76, s76, 128
    v_mfma_f32_16x16x32_bf16 v[100:103], v[144:147], v[116:119], v[100:103]
    s_cmp_ge_u32 s76, s77
    s_cselect_b32 s55, 1280, 0
    v_mfma_f32_16x16x32_bf16 v[104:107], v[144:147], v[120:123], v[104:107]
    s_sub_u32 s76, s76, s55
    buffer_load_dwordx4 v232, s[24:27], s76 offen offset:0 lds
    v_mfma_f32_16x16x32_bf16 v[108:111], v[144:147], v[124:127], v[108:111]
    s_waitcnt vmcnt(10)
    s_waitcnt lgkmcnt(0)
    s_barrier
    v_mfma_f32_16x16x32_bf16 v[32:35], v[164:167], v[148:151], v[32:35]
    ds_read_b128 v[112:115], v243 offset:36864
    ds_read_b64_tr_b16 v[128:129], v247 offset:40960
    v_mfma_f32_16x16x32_bf16 v[36:39], v[164:167], v[152:155], v[36:39]
    ds_read_b64_tr_b16 v[130:131], v247 offset:42240
    ds_read_b128 v[116:119], v243 offset:38912
    v_mfma_f32_16x16x32_bf16 v[40:43], v[164:167], v[156:159], v[40:43]
    ds_read_b64_tr_b16 v[132:133], v248 offset:40960
    ds_read_b64_tr_b16 v[134:135], v248 offset:42240
    v_mfma_f32_16x16x32_bf16 v[44:47], v[164:167], v[160:163], v[44:47]
    v_mfma_f32_16x16x32_bf16 v[48:51], v[168:171], v[148:151], v[48:51]
    ds_read_b128 v[120:123], v243 offset:46080
    ds_read_b64_tr_b16 v[136:137], v247 offset:41024
    v_mfma_f32_16x16x32_bf16 v[52:55], v[168:171], v[152:155], v[52:55]
    ds_read_b64_tr_b16 v[138:139], v247 offset:42304
    buffer_load_dwordx4 v233, s[24:27], s76 offen offset:1024 lds
    v_mfma_f32_16x16x32_bf16 v[56:59], v[168:171], v[156:159], v[56:59]
    v_mfma_f32_16x16x32_bf16 v[60:63], v[168:171], v[160:163], v[60:63]
    v_mfma_f32_16x16x32_bf16 v[64:67], v[172:175], v[148:151], v[64:67]
    ds_read_b128 v[124:127], v243 offset:48128
    ds_read_b64_tr_b16 v[140:141], v248 offset:41024
    v_mfma_f32_16x16x32_bf16 v[68:71], v[172:175], v[152:155], v[68:71]
    ds_read_b64_tr_b16 v[142:143], v248 offset:42304
    ds_read_b64_tr_b16 v[144:145], v247 offset:41088
    v_mfma_f32_16x16x32_bf16 v[72:75], v[172:175], v[156:159], v[72:75]
    ds_read_b64_tr_b16 v[146:147], v247 offset:42368
    buffer_load_dwordx4 v234, s[24:27], s76 offen offset:2048 lds
    v_mfma_f32_16x16x32_bf16 v[76:79], v[172:175], v[160:163], v[76:79]
    v_mfma_f32_16x16x32_bf16 v[80:83], v[176:179], v[148:151], v[80:83]
    buffer_load_dwordx4 v235, s[24:27], s76 offen offset:3072 lds
    v_mfma_f32_16x16x32_bf16 v[84:87], v[176:179], v[152:155], v[84:87]
    v_mfma_f32_16x16x32_bf16 v[88:91], v[176:179], v[156:159], v[88:91]
    v_mfma_f32_16x16x32_bf16 v[92:95], v[176:179], v[160:163], v[92:95]
    v_mfma_f32_16x16x32_bf16 v[96:99], v[180:183], v[148:151], v[96:99]
    s_add_u32 m0, s92, 40960
    s_add_u32 s78, s78, 81920
    v_mfma_f32_16x16x32_bf16 v[100:103], v[180:183], v[152:155], v[100:103]
    s_cmp_ge_u32 s78, 819200
    s_cselect_b32 s55, 819200, 0
    v_mfma_f32_16x16x32_bf16 v[104:107], v[180:183], v[156:159], v[104:107]
    s_sub_u32 s78, s78, s55
    buffer_load_dwordx4 v236, s[28:31], s78 offen offset:0 lds
    v_mfma_f32_16x16x32_bf16 v[108:111], v[180:183], v[160:163], v[108:111]
    s_waitcnt lgkmcnt(4)
    v_mfma_f32_16x16x32_bf16 v[32:35], v[128:131], v[112:115], v[32:35]
    ds_read_b128 v[148:151], v244 offset:36864
    ds_read_b64_tr_b16 v[164:165], v247 offset:59392
    v_mfma_f32_16x16x32_bf16 v[36:39], v[128:131], v[116:119], v[36:39]
    ds_read_b64_tr_b16 v[166:167], v247 offset:60672
    ds_read_b128 v[152:155], v244 offset:38912
    v_mfma_f32_16x16x32_bf16 v[40:43], v[128:131], v[120:123], v[40:43]
    ds_read_b64_tr_b16 v[168:169], v248 offset:59392
    ds_read_b64_tr_b16 v[170:171], v248 offset:60672
    v_mfma_f32_16x16x32_bf16 v[44:47], v[128:131], v[124:127], v[44:47]
    buffer_load_dwordx4 v237, s[28:31], s78 offen offset:1024 lds
    v_mfma_f32_16x16x32_bf16 v[48:51], v[132:135], v[112:115], v[48:51]
    ds_read_b128 v[156:159], v244 offset:46080
    ds_read_b64_tr_b16 v[172:173], v247 offset:59456
    v_mfma_f32_16x16x32_bf16 v[52:55], v[132:135], v[116:119], v[52:55]
    ds_read_b64_tr_b16 v[174:175], v247 offset:60736
    buffer_load_dwordx4 v238, s[28:31], s78 offen offset:2048 lds
    v_mfma_f32_16x16x32_bf16 v[56:59], v[132:135], v[120:123], v[56:59]
    v_mfma_f32_16x16x32_bf16 v[60:63], v[132:135], v[124:127], v[60:63]
    v_mfma_f32_16x16x32_bf16 v[64:67], v[136:139], v[112:115], v[64:67]
    ds_read_b128 v[160:163], v244 offset:48128
    ds_read_b64_tr_b16 v[176:177], v248 offset:59456
    v_mfma_f32_16x16x32_bf16 v[68:71], v[136:139], v[116:119], v[68:71]
    s_waitcnt lgkmcnt(14)
    ds_read_b64_tr_b16 v[178:179], v248 offset:60736
    v_mfma_f32_16x16x32_bf16 v[72:75], v[136:139], v[120:123], v[72:75]
    s_waitcnt lgkmcnt(14)
    ds_read_b64_tr_b16 v[180:181], v247 offset:59520
    v_mfma_f32_16x16x32_bf16 v[76:79], v[136:139], v[124:127], v[76:79]
    s_waitcnt lgkmcnt(14)
    ds_read_b64_tr_b16 v[182:183], v247 offset:60800
    buffer_load_dwordx4 v239, s[28:31], s78 offen offset:3072 lds
    v_mfma_f32_16x16x32_bf16 v[80:83], v[140:143], v[112:115], v[80:83]
    s_add_u32 m0, s92, 45056
    s_nop 0
    v_mfma_f32_16x16x32_bf16 v[84:87], v[140:143], v[116:119], v[84:87]
    buffer_load_dwordx4 v240, s[28:31], s78 offen offset:0 lds
    s_waitcnt lgkmcnt(14)
    v_mfma_f32_16x16x32_bf16 v[88:91], v[140:143], v[120:123], v[88:91]
    v_mfma_f32_16x16x32_bf16 v[92:95], v[140:143], v[124:127], v[92:95]
    v_mfma_f32_16x16x32_bf16 v[96:99], v[144:147], v[112:115], v[96:99]
    s_add_u32 m0, s92, 73728
    s_add_u32 s76, s76, 128
    v_mfma_f32_16x16x32_bf16 v[100:103], v[144:147], v[116:119], v[100:103]
    s_cmp_ge_u32 s76, s77
    s_cselect_b32 s55, 1280, 0
    v_mfma_f32_16x16x32_bf16 v[104:107], v[144:147], v[120:123], v[104:107]
    s_sub_u32 s76, s76, s55
    buffer_load_dwordx4 v232, s[24:27], s76 offen offset:0 lds
    v_mfma_f32_16x16x32_bf16 v[108:111], v[144:147], v[124:127], v[108:111]
    s_waitcnt vmcnt(10)
    s_waitcnt lgkmcnt(0)
    s_barrier
    v_mfma_f32_16x16x32_bf16 v[32:35], v[164:167], v[148:151], v[32:35]
    ds_read_b128 v[112:115], v241 offset:0
    ds_read_b64_tr_b16 v[128:129], v245 offset:4096
    v_mfma_f32_16x16x32_bf16 v[36:39], v[164:167], v[152:155], v[36:39]
    ds_read_b64_tr_b16 v[130:131], v245 offset:5376
    ds_read_b128 v[116:119], v241 offset:2048
    v_mfma_f32_16x16x32_bf16 v[40:43], v[164:167], v[156:159], v[40:43]
    ds_read_b64_tr_b16 v[132:133], v246 offset:4096
    ds_read_b64_tr_b16 v[134:135], v246 offset:5376
    v_mfma_f32_16x16x32_bf16 v[44:47], v[164:167], v[160:163], v[44:47]
    v_mfma_f32_16x16x32_bf16 v[48:51], v[168:171], v[148:151], v[48:51]
    ds_read_b128 v[120:123], v241 offset:9216
    ds_read_b64_tr_b16 v[136:137], v245 offset:4160
    v_mfma_f32_16x16x32_bf16 v[52:55], v[168:171], v[152:155], v[52:55]
    ds_read_b64_tr_b16 v[138:139], v245 offset:5440
    buffer_load_dwordx4 v233, s[24:27], s76 offen offset:1024 lds
    v_mfma_f32_16x16x32_bf16 v[56:59], v[168:171], v[156:159], v[56:59]
    v_mfma_f32_16x16x32_bf16 v[60:63], v[168:171], v[160:163], v[60:63]
    v_mfma_f32_16x16x32_bf16 v[64:67], v[172:175], v[148:151], v[64:67]
    ds_read_b128 v[124:127], v241 offset:11264
    ds_read_b64_tr_b16 v[140:141], v246 offset:4160
    v_mfma_f32_16x16x32_bf16 v[68:71], v[172:175], v[152:155], v[68:71]
    ds_read_b64_tr_b16 v[142:143], v246 offset:5440
    ds_read_b64_tr_b16 v[144:145], v245 offset:4224
    v_mfma_f32_16x16x32_bf16 v[72:75], v[172:175], v[156:159], v[72:75]
    ds_read_b64_tr_b16 v[146:147], v245 offset:5504
    buffer_load_dwordx4 v234, s[24:27], s76 offen offset:2048 lds
    v_mfma_f32_16x16x32_bf16 v[76:79], v[172:175], v[160:163], v[76:79]
    v_mfma_f32_16x16x32_bf16 v[80:83], v[176:179], v[148:151], v[80:83]
    buffer_load_dwordx4 v235, s[24:27], s76 offen offset:3072 lds
    v_mfma_f32_16x16x32_bf16 v[84:87], v[176:179], v[152:155], v[84:87]
    v_mfma_f32_16x16x32_bf16 v[88:91], v[176:179], v[156:159], v[88:91]
    v_mfma_f32_16x16x32_bf16 v[92:95], v[176:179], v[160:163], v[92:95]
    v_mfma_f32_16x16x32_bf16 v[96:99], v[180:183], v[148:151], v[96:99]
    s_add_u32 m0, s92, 77824
    s_add_u32 s78, s78, 81920
    v_mfma_f32_16x16x32_bf16 v[100:103], v[180:183], v[152:155], v[100:103]
    s_cmp_ge_u32 s78, 819200
    s_cselect_b32 s55, 819200, 0
    v_mfma_f32_16x16x32_bf16 v[104:107], v[180:183], v[156:159], v[104:107]
    s_sub_u32 s78, s78, s55
    buffer_load_dwordx4 v236, s[28:31], s78 offen offset:0 lds
    v_mfma_f32_16x16x32_bf16 v[108:111], v[180:183], v[160:163], v[108:111]
    s_waitcnt lgkmcnt(4)
    v_mfma_f32_16x16x32_bf16 v[32:35], v[128:131], v[112:115], v[32:35]
    ds_read_b128 v[148:151], v242 offset:0
    ds_read_b64_tr_b16 v[164:165], v245 offset:22528
    v_mfma_f32_16x16x32_bf16 v[36:39], v[128:131], v[116:119], v[36:39]
    ds_read_b64_tr_b16 v[166:167], v245 offset:23808
    ds_read_b128 v[152:155], v242 offset:2048
    v_mfma_f32_16x16x32_bf16 v[40:43], v[128:131], v[120:123], v[40:43]
    ds_read_b64_tr_b16 v[168:169], v246 offset:22528
    ds_read_b64_tr_b16 v[170:171], v246 offset:23808
    v_mfma_f32_16x16x32_bf16 v[44:47], v[128:131], v[124:127], v[44:47]
    buffer_load_dwordx4 v237, s[28:31], s78 offen offset:1024 lds
    v_mfma_f32_16x16x32_bf16 v[48:51], v[132:135], v[112:115], v[48:51]
    ds_read_b128 v[156:159], v242 offset:9216
    ds_read_b64_tr_b16 v[172:173], v245 offset:22592
    v_mfma_f32_16x16x32_bf16 v[52:55], v[132:135], v[116:119], v[52:55]
    ds_read_b64_tr_b16 v[174:175], v245 offset:23872
    buffer_load_dwordx4 v238, s[28:31], s78 offen offset:2048 lds
    v_mfma_f32_16x16x32_bf16 v[56:59], v[132:135], v[120:123], v[56:59]
    v_mfma_f32_16x16x32_bf16 v[60:63], v[132:135], v[124:127], v[60:63]
    v_mfma_f32_16x16x32_bf16 v[64:67], v[136:139], v[112:115], v[64:67]
    ds_read_b128 v[160:163], v242 offset:11264
    ds_read_b64_tr_b16 v[176:177], v246 offset:22592
    v_mfma_f32_16x16x32_bf16 v[68:71], v[136:139], v[116:119], v[68:71]
    s_waitcnt lgkmcnt(14)
    ds_read_b64_tr_b16 v[178:179], v246 offset:23872
    v_mfma_f32_16x16x32_bf16 v[72:75], v[136:139], v[120:123], v[72:75]
    s_waitcnt lgkmcnt(14)
    ds_read_b64_tr_b16 v[180:181], v245 offset:22656
    v_mfma_f32_16x16x32_bf16 v[76:79], v[136:139], v[124:127], v[76:79]
    s_waitcnt lgkmcnt(14)
    ds_read_b64_tr_b16 v[182:183], v245 offset:23936
    buffer_load_dwordx4 v239, s[28:31], s78 offen offset:3072 lds
    v_mfma_f32_16x16x32_bf16 v[80:83], v[140:143], v[112:115], v[80:83]
    s_add_u32 m0, s92, 81920
    s_nop 0
    v_mfma_f32_16x16x32_bf16 v[84:87], v[140:143], v[116:119], v[84:87]
    buffer_load_dwordx4 v240, s[28:31], s78 offen offset:0 lds
    s_waitcnt lgkmcnt(14)
    v_mfma_f32_16x16x32_bf16 v[88:91], v[140:143], v[120:123], v[88:91]
    v_mfma_f32_16x16x32_bf16 v[92:95], v[140:143], v[124:127], v[92:95]
    v_mfma_f32_16x16x32_bf16 v[96:99], v[144:147], v[112:115], v[96:99]
    s_add_u32 m0, s92, 110592
    s_add_u32 s76, s76, 128
    v_mfma_f32_16x16x32_bf16 v[100:103], v[144:147], v[116:119], v[100:103]
    s_cmp_ge_u32 s76, s77
    s_cselect_b32 s55, 1280, 0
    v_mfma_f32_16x16x32_bf16 v[104:107], v[144:147], v[120:123], v[104:107]
    s_sub_u32 s76, s76, s55
    buffer_load_dwordx4 v232, s[24:27], s76 offen offset:0 lds
    v_mfma_f32_16x16x32_bf16 v[108:111], v[144:147], v[124:127], v[108:111]
    s_waitcnt vmcnt(10)
    s_waitcnt lgkmcnt(0)
    s_barrier
    v_mfma_f32_16x16x32_bf16 v[32:35], v[164:167], v[148:151], v[32:35]
    ds_read_b128 v[112:115], v241 offset:36864
    ds_read_b64_tr_b16 v[128:129], v245 offset:40960
    v_mfma_f32_16x16x32_bf16 v[36:39], v[164:167], v[152:155], v[36:39]
    ds_read_b64_tr_b16 v[130:131], v245 offset:42240
    ds_read_b128 v[116:119], v241 offset:38912
    v_mfma_f32_16x16x32_bf16 v[40:43], v[164:167], v[156:159], v[40:43]
    ds_read_b64_tr_b16 v[132:133], v246 offset:40960
    ds_read_b64_tr_b16 v[134:135], v246 offset:42240
    v_mfma_f32_16x16x32_bf16 v[44:47], v[164:167], v[160:163], v[44:47]
    v_mfma_f32_16x16x32_bf16 v[48:51], v[168:171], v[148:151], v[48:51]
    ds_read_b128 v[120:123], v241 offset:46080
    ds_read_b64_tr_b16 v[136:137], v245 offset:41024
    v_mfma_f32_16x16x32_bf16 v[52:55], v[168:171], v[152:155], v[52:55]
    ds_read_b64_tr_b16 v[138:139], v245 offset:42304
    buffer_load_dwordx4 v233, s[24:27], s76 offen offset:1024 lds
    v_mfma_f32_16x16x32_bf16 v[56:59], v[168:171], v[156:159], v[56:59]
    v_mfma_f32_16x16x32_bf16 v[60:63], v[168:171], v[160:163], v[60:63]
    v_mfma_f32_16x16x32_bf16 v[64:67], v[172:175], v[148:151], v[64:67]
    ds_read_b128 v[124:127], v241 offset:48128
    ds_read_b64_tr_b16 v[140:141], v246 offset:41024
    v_mfma_f32_16x16x32_bf16 v[68:71], v[172:175], v[152:155], v[68:71]
    ds_read_b64_tr_b16 v[142:143], v246 offset:42304
    ds_read_b64_tr_b16 v[144:145], v245 offset:41088
    v_mfma_f32_16x16x32_bf16 v[72:75], v[172:175], v[156:159], v[72:75]
    ds_read_b64_tr_b16 v[146:147], v245 offset:42368
    buffer_load_dwordx4 v234, s[24:27], s76 offen offset:2048 lds
    v_mfma_f32_16x16x32_bf16 v[76:79], v[172:175], v[160:163], v[76:79]
    v_mfma_f32_16x16x32_bf16 v[80:83], v[176:179], v[148:151], v[80:83]
    buffer_load_dwordx4 v235, s[24:27], s76 offen offset:3072 lds
    v_mfma_f32_16x16x32_bf16 v[84:87], v[176:179], v[152:155], v[84:87]
    v_mfma_f32_16x16x32_bf16 v[88:91], v[176:179], v[156:159], v[88:91]
    v_mfma_f32_16x16x32_bf16 v[92:95], v[176:179], v[160:163], v[92:95]
    v_mfma_f32_16x16x32_bf16 v[96:99], v[180:183], v[148:151], v[96:99]
    s_add_u32 m0, s92, 114688
    s_add_u32 s78, s78, 81920
    v_mfma_f32_16x16x32_bf16 v[100:103], v[180:183], v[152:155], v[100:103]
    s_cmp_ge_u32 s78, 819200
    s_cselect_b32 s55, 819200, 0
    v_mfma_f32_16x16x32_bf16 v[104:107], v[180:183], v[156:159], v[104:107]
    s_sub_u32 s78, s78, s55
    buffer_load_dwordx4 v236, s[28:31], s78 offen offset:0 lds
    v_mfma_f32_16x16x32_bf16 v[108:111], v[180:183], v[160:163], v[108:111]
    s_waitcnt lgkmcnt(4)
    v_mfma_f32_16x16x32_bf16 v[32:35], v[128:131], v[112:115], v[32:35]
    ds_read_b128 v[148:151], v242 offset:36864
    ds_read_b64_tr_b16 v[164:165], v245 offset:59392
    v_mfma_f32_16x16x32_bf16 v[36:39], v[128:131], v[116:119], v[36:39]
    ds_read_b64_tr_b16 v[166:167], v245 offset:60672
    ds_read_b128 v[152:155], v242 offset:38912
    v_mfma_f32_16x16x32_bf16 v[40:43], v[128:131], v[120:123], v[40:43]
    ds_read_b64_tr_b16 v[168:169], v246 offset:59392
    ds_read_b64_tr_b16 v[170:171], v246 offset:60672
    v_mfma_f32_16x16x32_bf16 v[44:47], v[128:131], v[124:127], v[44:47]
    buffer_load_dwordx4 v237, s[28:31], s78 offen offset:1024 lds
    v_mfma_f32_16x16x32_bf16 v[48:51], v[132:135], v[112:115], v[48:51]
    ds_read_b128 v[156:159], v242 offset:46080
    ds_read_b64_tr_b16 v[172:173], v245 offset:59456
    v_mfma_f32_16x16x32_bf16 v[52:55], v[132:135], v[116:119], v[52:55]
    ds_read_b64_tr_b16 v[174:175], v245 offset:60736
    buffer_load_dwordx4 v238, s[28:31], s78 offen offset:2048 lds
    v_mfma_f32_16x16x32_bf16 v[56:59], v[132:135], v[120:123], v[56:59]
    v_mfma_f32_16x16x32_bf16 v[60:63], v[132:135], v[124:127], v[60:63]
    v_mfma_f32_16x16x32_bf16 v[64:67], v[136:139], v[112:115], v[64:67]
    ds_read_b128 v[160:163], v242 offset:48128
    ds_read_b64_tr_b16 v[176:177], v246 offset:59456
    v_mfma_f32_16x16x32_bf16 v[68:71], v[136:139], v[116:119], v[68:71]
    s_waitcnt lgkmcnt(14)
    ds_read_b64_tr_b16 v[178:179], v246 offset:60736
    v_mfma_f32_16x16x32_bf16 v[72:75], v[136:139], v[120:123], v[72:75]
    s_waitcnt lgkmcnt(14)
    ds_read_b64_tr_b16 v[180:181], v245 offset:59520
    v_mfma_f32_16x16x32_bf16 v[76:79], v[136:139], v[124:127], v[76:79]
    s_waitcnt lgkmcnt(14)
    ds_read_b64_tr_b16 v[182:183], v245 offset:60800
    buffer_load_dwordx4 v239, s[28:31], s78 offen offset:3072 lds
    v_mfma_f32_16x16x32_bf16 v[80:83], v[140:143], v[112:115], v[80:83]
    s_add_u32 m0, s92, 118784
    s_nop 0
    v_mfma_f32_16x16x32_bf16 v[84:87], v[140:143], v[116:119], v[84:87]
    buffer_load_dwordx4 v240, s[28:31], s78 offen offset:0 lds
    s_waitcnt lgkmcnt(14)
    v_mfma_f32_16x16x32_bf16 v[88:91], v[140:143], v[120:123], v[88:91]
    v_mfma_f32_16x16x32_bf16 v[92:95], v[140:143], v[124:127], v[92:95]
    v_mfma_f32_16x16x32_bf16 v[96:99], v[144:147], v[112:115], v[96:99]
    s_add_u32 m0, s92, 0
    s_add_u32 s76, s76, 128
    v_mfma_f32_16x16x32_bf16 v[100:103], v[144:147], v[116:119], v[100:103]
    s_cmp_ge_u32 s76, s77
    s_cselect_b32 s55, 1280, 0
    v_mfma_f32_16x16x32_bf16 v[104:107], v[144:147], v[120:123], v[104:107]
    s_sub_u32 s76, s76, s55
    buffer_load_dwordx4 v232, s[24:27], s76 offen offset:0 lds
    v_mfma_f32_16x16x32_bf16 v[108:111], v[144:147], v[124:127], v[108:111]
    s_waitcnt vmcnt(10)
    s_waitcnt lgkmcnt(0)
    s_barrier
    v_mfma_f32_16x16x32_bf16 v[32:35], v[164:167], v[148:151], v[32:35]
    ds_read_b128 v[112:115], v243 offset:0
    ds_read_b64_tr_b16 v[128:129], v247 offset:4096
    v_mfma_f32_16x16x32_bf16 v[36:39], v[164:167], v[152:155], v[36:39]
    ds_read_b64_tr_b16 v[130:131], v247 offset:5376
    ds_read_b128 v[116:119], v243 offset:2048
    v_mfma_f32_16x16x32_bf16 v[40:43], v[164:167], v[156:159], v[40:43]
    ds_read_b64_tr_b16 v[132:133], v248 offset:4096
    ds_read_b64_tr_b16 v[134:135], v248 offset:5376
    v_mfma_f32_16x16x32_bf16 v[44:47], v[164:167], v[160:163], v[44:47]
    v_mfma_f32_16x16x32_bf16 v[48:51], v[168:171], v[148:151], v[48:51]
    ds_read_b128 v[120:123], v243 offset:9216
    ds_read_b64_tr_b16 v[136:137], v247 offset:4160
    v_mfma_f32_16x16x32_bf16 v[52:55], v[168:171], v[152:155], v[52:55]
    ds_read_b64_tr_b16 v[138:139], v247 offset:5440
    buffer_load_dwordx4 v233, s[24:27], s76 offen offset:1024 lds
    v_mfma_f32_16x16x32_bf16 v[56:59], v[168:171], v[156:159], v[56:59]
    v_mfma_f32_16x16x32_bf16 v[60:63], v[168:171], v[160:163], v[60:63]
    v_mfma_f32_16x16x32_bf16 v[64:67], v[172:175], v[148:151], v[64:67]
    ds_read_b128 v[124:127], v243 offset:11264
    ds_read_b64_tr_b16 v[140:141], v248 offset:4160
    v_mfma_f32_16x16x32_bf16 v[68:71], v[172:175], v[152:155], v[68:71]
    ds_read_b64_tr_b16 v[142:143], v248 offset:5440
    ds_read_b64_tr_b16 v[144:145], v247 offset:4224
    v_mfma_f32_16x16x32_bf16 v[72:75], v[172:175], v[156:159], v[72:75]
    ds_read_b64_tr_b16 v[146:147], v247 offset:5504
    buffer_load_dwordx4 v234, s[24:27], s76 offen offset:2048 lds
    v_mfma_f32_16x16x32_bf16 v[76:79], v[172:175], v[160:163], v[76:79]
    v_mfma_f32_16x16x32_bf16 v[80:83], v[176:179], v[148:151], v[80:83]
    buffer_load_dwordx4 v235, s[24:27], s76 offen offset:3072 lds
    v_mfma_f32_16x16x32_bf16 v[84:87], v[176:179], v[152:155], v[84:87]
    v_mfma_f32_16x16x32_bf16 v[88:91], v[176:179], v[156:159], v[88:91]
    v_mfma_f32_16x16x32_bf16 v[92:95], v[176:179], v[160:163], v[92:95]
    v_mfma_f32_16x16x32_bf16 v[96:99], v[180:183], v[148:151], v[96:99]
    s_add_u32 m0, s92, 4096
    s_add_u32 s78, s78, 81920
    v_mfma_f32_16x16x32_bf16 v[100:103], v[180:183], v[152:155], v[100:103]
    s_cmp_ge_u32 s78, 819200
    s_cselect_b32 s55, 819200, 0
    v_mfma_f32_16x16x32_bf16 v[104:107], v[180:183], v[156:159], v[104:107]
    s_sub_u32 s78, s78, s55
    buffer_load_dwordx4 v236, s[28:31], s78 offen offset:0 lds
    v_mfma_f32_16x16x32_bf16 v[108:111], v[180:183], v[160:163], v[108:111]
    s_waitcnt lgkmcnt(4)
    v_mfma_f32_16x16x32_bf16 v[32:35], v[128:131], v[112:115], v[32:35]
    ds_read_b128 v[148:151], v244 offset:0
    ds_read_b64_tr_b16 v[164:165], v247 offset:22528
    v_mfma_f32_16x16x32_bf16 v[36:39], v[128:131], v[116:119], v[36:39]
    ds_read_b64_tr_b16 v[166:167], v247 offset:23808
    ds_read_b128 v[152:155], v244 offset:2048
    v_mfma_f32_16x16x32_bf16 v[40:43], v[128:131], v[120:123], v[40:43]
    ds_read_b64_tr_b16 v[168:169], v248 offset:22528
    ds_read_b64_tr_b16 v[170:171], v248 offset:23808
    v_mfma_f32_16x16x32_bf16 v[44:47], v[128:131], v[124:127], v[44:47]
    buffer_load_dwordx4 v237, s[28:31], s78 offen offset:1024 lds
    v_mfma_f32_16x16x32_bf16 v[48:51], v[132:135], v[112:115], v[48:51]
    ds_read_b128 v[156:159], v244 offset:9216
    ds_read_b64_tr_b16 v[172:173], v247 offset:22592
    v_mfma_f32_16x16x32_bf16 v[52:55], v[132:135], v[116:119], v[52:55]
    ds_read_b64_tr_b16 v[174:175], v247 offset:23872
    buffer_load_dwordx4 v238, s[28:31], s78 offen offset:2048 lds
    v_mfma_f32_16x16x32_bf16 v[56:59], v[132:135], v[120:123], v[56:59]
    v_mfma_f32_16x16x32_bf16 v[60:63], v[132:135], v[124:127], v[60:63]
    v_mfma_f32_16x16x32_bf16 v[64:67], v[136:139], v[112:115], v[64:67]
    ds_read_b128 v[160:163], v244 offset:11264
    ds_read_b64_tr_b16 v[176:177], v248 offset:22592
    v_mfma_f32_16x16x32_bf16 v[68:71], v[136:139], v[116:119], v[68:71]
    s_waitcnt lgkmcnt(14)
    ds_read_b64_tr_b16 v[178:179], v248 offset:23872
    v_mfma_f32_16x16x32_bf16 v[72:75], v[136:139], v[120:123], v[72:75]
    s_waitcnt lgkmcnt(14)
    ds_read_b64_tr_b16 v[180:181], v247 offset:22656
    v_mfma_f32_16x16x32_bf16 v[76:79], v[136:139], v[124:127], v[76:79]
    s_waitcnt lgkmcnt(14)
    ds_read_b64_tr_b16 v[182:183], v247 offset:23936
    buffer_load_dwordx4 v239, s[28:31], s78 offen offset:3072 lds
    v_mfma_f32_16x16x32_bf16 v[80:83], v[140:143], v[112:115], v[80:83]
    s_add_u32 m0, s92, 8192
    s_nop 0
    v_mfma_f32_16x16x32_bf16 v[84:87], v[140:143], v[116:119], v[84:87]
    buffer_load_dwordx4 v240, s[28:31], s78 offen offset:0 lds
    global_load_dword v24, v25, s[18:19]
    v_mfma_f32_16x16x32_bf16 v[88:91], v[140:143], v[120:123], v[88:91]
    s_waitcnt lgkmcnt(14)
    v_mfma_f32_16x16x32_bf16 v[92:95], v[140:143], v[124:127], v[92:95]
    v_mfma_f32_16x16x32_bf16 v[96:99], v[144:147], v[112:115], v[96:99]
    s_add_u32 m0, s92, 36864
    s_add_u32 s76, s76, 128
    v_mfma_f32_16x16x32_bf16 v[100:103], v[144:147], v[116:119], v[100:103]
    s_cmp_ge_u32 s76, s77
    s_cselect_b32 s55, 1280, 0
    v_mfma_f32_16x16x32_bf16 v[104:107], v[144:147], v[120:123], v[104:107]
    s_sub_u32 s76, s76, s55
    buffer_load_dwordx4 v232, s[24:27], s76 offen offset:0 lds
    v_mfma_f32_16x16x32_bf16 v[108:111], v[144:147], v[124:127], v[108:111]
    s_waitcnt vmcnt(11)
    s_waitcnt lgkmcnt(0)
    s_barrier
    v_mfma_f32_16x16x32_bf16 v[32:35], v[164:167], v[148:151], v[32:35]
    ds_read_b128 v[112:115], v243 offset:36864
    ds_read_b64_tr_b16 v[128:129], v247 offset:40960
    v_mfma_f32_16x16x32_bf16 v[36:39], v[164:167], v[152:155], v[36:39]
    ds_read_b64_tr_b16 v[130:131], v247 offset:42240
    ds_read_b128 v[116:119], v243 offset:38912
    v_mfma_f32_16x16x32_bf16 v[40:43], v[164:167], v[156:159], v[40:43]
    ds_read_b64_tr_b16 v[132:133], v248 offset:40960
    ds_read_b64_tr_b16 v[134:135], v248 offset:42240
    v_mfma_f32_16x16x32_bf16 v[44:47], v[164:167], v[160:163], v[44:47]
    v_mfma_f32_16x16x32_bf16 v[48:51], v[168:171], v[148:151], v[48:51]
    ds_read_b128 v[120:123], v243 offset:46080
    ds_read_b64_tr_b16 v[136:137], v247 offset:41024
    v_mfma_f32_16x16x32_bf16 v[52:55], v[168:171], v[152:155], v[52:55]
    ds_read_b64_tr_b16 v[138:139], v247 offset:42304
    buffer_load_dwordx4 v233, s[24:27], s76 offen offset:1024 lds
    v_mfma_f32_16x16x32_bf16 v[56:59], v[168:171], v[156:159], v[56:59]
    v_mfma_f32_16x16x32_bf16 v[60:63], v[168:171], v[160:163], v[60:63]
    v_mfma_f32_16x16x32_bf16 v[64:67], v[172:175], v[148:151], v[64:67]
    ds_read_b128 v[124:127], v243 offset:48128
    ds_read_b64_tr_b16 v[140:141], v248 offset:41024
    v_mfma_f32_16x16x32_bf16 v[68:71], v[172:175], v[152:155], v[68:71]
    ds_read_b64_tr_b16 v[142:143], v248 offset:42304
    ds_read_b64_tr_b16 v[144:145], v247 offset:41088
    v_mfma_f32_16x16x32_bf16 v[72:75], v[172:175], v[156:159], v[72:75]
    ds_read_b64_tr_b16 v[146:147], v247 offset:42368
    buffer_load_dwordx4 v234, s[24:27], s76 offen offset:2048 lds
    v_mfma_f32_16x16x32_bf16 v[76:79], v[172:175], v[160:163], v[76:79]
    v_mfma_f32_16x16x32_bf16 v[80:83], v[176:179], v[148:151], v[80:83]
    buffer_load_dwordx4 v235, s[24:27], s76 offen offset:3072 lds
    v_mfma_f32_16x16x32_bf16 v[84:87], v[176:179], v[152:155], v[84:87]
    v_mfma_f32_16x16x32_bf16 v[88:91], v[176:179], v[156:159], v[88:91]
    v_mfma_f32_16x16x32_bf16 v[92:95], v[176:179], v[160:163], v[92:95]
    v_mfma_f32_16x16x32_bf16 v[96:99], v[180:183], v[148:151], v[96:99]
    s_add_u32 m0, s92, 40960
    s_add_u32 s78, s78, 81920
    v_mfma_f32_16x16x32_bf16 v[100:103], v[180:183], v[152:155], v[100:103]
    s_cmp_ge_u32 s78, 819200
    s_cselect_b32 s55, 819200, 0
    v_mfma_f32_16x16x32_bf16 v[104:107], v[180:183], v[156:159], v[104:107]
    s_sub_u32 s78, s78, s55
    buffer_load_dwordx4 v236, s[28:31], s78 offen offset:0 lds
    v_mfma_f32_16x16x32_bf16 v[108:111], v[180:183], v[160:163], v[108:111]
    s_waitcnt lgkmcnt(4)
    v_mfma_f32_16x16x32_bf16 v[32:35], v[128:131], v[112:115], v[32:35]
    ds_read_b128 v[148:151], v244 offset:36864
    ds_read_b64_tr_b16 v[164:165], v247 offset:59392
    v_mfma_f32_16x16x32_bf16 v[36:39], v[128:131], v[116:119], v[36:39]
    ds_read_b64_tr_b16 v[166:167], v247 offset:60672
    ds_read_b128 v[152:155], v244 offset:38912
    v_mfma_f32_16x16x32_bf16 v[40:43], v[128:131], v[120:123], v[40:43]
    ds_read_b64_tr_b16 v[168:169], v248 offset:59392
    ds_read_b64_tr_b16 v[170:171], v248 offset:60672
    v_mfma_f32_16x16x32_bf16 v[44:47], v[128:131], v[124:127], v[44:47]
    buffer_load_dwordx4 v237, s[28:31], s78 offen offset:1024 lds
    v_mfma_f32_16x16x32_bf16 v[48:51], v[132:135], v[112:115], v[48:51]
    ds_read_b128 v[156:159], v244 offset:46080
    ds_read_b64_tr_b16 v[172:173], v247 offset:59456
    v_mfma_f32_16x16x32_bf16 v[52:55], v[132:135], v[116:119], v[52:55]
    ds_read_b64_tr_b16 v[174:175], v247 offset:60736
    buffer_load_dwordx4 v238, s[28:31], s78 offen offset:2048 lds
    v_mfma_f32_16x16x32_bf16 v[56:59], v[132:135], v[120:123], v[56:59]
    v_mfma_f32_16x16x32_bf16 v[60:63], v[132:135], v[124:127], v[60:63]
    v_mfma_f32_16x16x32_bf16 v[64:67], v[136:139], v[112:115], v[64:67]
    ds_read_b128 v[160:163], v244 offset:48128
    ds_read_b64_tr_b16 v[176:177], v248 offset:59456
    v_mfma_f32_16x16x32_bf16 v[68:71], v[136:139], v[116:119], v[68:71]
    s_waitcnt lgkmcnt(14)
    ds_read_b64_tr_b16 v[178:179], v248 offset:60736
    v_mfma_f32_16x16x32_bf16 v[72:75], v[136:139], v[120:123], v[72:75]
    s_waitcnt lgkmcnt(14)
    ds_read_b64_tr_b16 v[180:181], v247 offset:59520
    v_mfma_f32_16x16x32_bf16 v[76:79], v[136:139], v[124:127], v[76:79]
    s_waitcnt lgkmcnt(14)
    ds_read_b64_tr_b16 v[182:183], v247 offset:60800
    buffer_load_dwordx4 v239, s[28:31], s78 offen offset:3072 lds
    v_mfma_f32_16x16x32_bf16 v[80:83], v[140:143], v[112:115], v[80:83]
    s_add_u32 m0, s92, 45056
    s_nop 0
    v_mfma_f32_16x16x32_bf16 v[84:87], v[140:143], v[116:119], v[84:87]
    buffer_load_dwordx4 v240, s[28:31], s78 offen offset:0 lds
    s_waitcnt lgkmcnt(14)
    v_mfma_f32_16x16x32_bf16 v[88:91], v[140:143], v[120:123], v[88:91]
    v_mfma_f32_16x16x32_bf16 v[92:95], v[140:143], v[124:127], v[92:95]
    v_mfma_f32_16x16x32_bf16 v[96:99], v[144:147], v[112:115], v[96:99]
    v_mfma_f32_16x16x32_bf16 v[100:103], v[144:147], v[116:119], v[100:103]
    v_mfma_f32_16x16x32_bf16 v[104:107], v[144:147], v[120:123], v[104:107]
    v_mfma_f32_16x16x32_bf16 v[108:111], v[144:147], v[124:127], v[108:111]
    s_waitcnt vmcnt(10)
    s_waitcnt lgkmcnt(0)
    s_barrier
    v_mfma_f32_16x16x32_bf16 v[32:35], v[164:167], v[148:151], v[32:35]
    ds_read_b128 v[112:115], v241 offset:0
    ds_read_b64_tr_b16 v[128:129], v245 offset:4096
    v_mfma_f32_16x16x32_bf16 v[36:39], v[164:167], v[152:155], v[36:39]
    ds_read_b64_tr_b16 v[130:131], v245 offset:5376
    ds_read_b128 v[116:119], v241 offset:2048
    v_mfma_f32_16x16x32_bf16 v[40:43], v[164:167], v[156:159], v[40:43]
    ds_read_b64_tr_b16 v[132:133], v246 offset:4096
    ds_read_b64_tr_b16 v[134:135], v246 offset:5376
    v_mfma_f32_16x16x32_bf16 v[44:47], v[164:167], v[160:163], v[44:47]
    v_mfma_f32_16x16x32_bf16 v[48:51], v[168:171], v[148:151], v[48:51]
    ds_read_b128 v[120:123], v241 offset:9216
    ds_read_b64_tr_b16 v[136:137], v245 offset:4160
    v_mfma_f32_16x16x32_bf16 v[52:55], v[168:171], v[152:155], v[52:55]
    ds_read_b64_tr_b16 v[138:139], v245 offset:5440
    v_mfma_f32_16x16x32_bf16 v[56:59], v[168:171], v[156:159], v[56:59]
    v_mfma_f32_16x16x32_bf16 v[60:63], v[168:171], v[160:163], v[60:63]
    v_mfma_f32_16x16x32_bf16 v[64:67], v[172:175], v[148:151], v[64:67]
    ds_read_b128 v[124:127], v241 offset:11264
    ds_read_b64_tr_b16 v[140:141], v246 offset:4160
    v_mfma_f32_16x16x32_bf16 v[68:71], v[172:175], v[152:155], v[68:71]
    ds_read_b64_tr_b16 v[142:143], v246 offset:5440
    ds_read_b64_tr_b16 v[144:145], v245 offset:4224
    v_mfma_f32_16x16x32_bf16 v[72:75], v[172:175], v[156:159], v[72:75]
    ds_read_b64_tr_b16 v[146:147], v245 offset:5504
    v_mfma_f32_16x16x32_bf16 v[76:79], v[172:175], v[160:163], v[76:79]
    v_mfma_f32_16x16x32_bf16 v[80:83], v[176:179], v[148:151], v[80:83]
    v_mfma_f32_16x16x32_bf16 v[84:87], v[176:179], v[152:155], v[84:87]
    v_mfma_f32_16x16x32_bf16 v[88:91], v[176:179], v[156:159], v[88:91]
    v_mfma_f32_16x16x32_bf16 v[92:95], v[176:179], v[160:163], v[92:95]
    v_mfma_f32_16x16x32_bf16 v[96:99], v[180:183], v[148:151], v[96:99]
    v_mfma_f32_16x16x32_bf16 v[100:103], v[180:183], v[152:155], v[100:103]
    v_mfma_f32_16x16x32_bf16 v[104:107], v[180:183], v[156:159], v[104:107]
    v_mfma_f32_16x16x32_bf16 v[108:111], v[180:183], v[160:163], v[108:111]
    s_waitcnt lgkmcnt(4)
    v_mfma_f32_16x16x32_bf16 v[32:35], v[128:131], v[112:115], v[32:35]
    ds_read_b128 v[148:151], v242 offset:0
    ds_read_b64_tr_b16 v[164:165], v245 offset:22528
    v_mfma_f32_16x16x32_bf16 v[36:39], v[128:131], v[116:119], v[36:39]
    ds_read_b64_tr_b16 v[166:167], v245 offset:23808
    ds_read_b128 v[152:155], v242 offset:2048
    v_mfma_f32_16x16x32_bf16 v[40:43], v[128:131], v[120:123], v[40:43]
    ds_read_b64_tr_b16 v[168:169], v246 offset:22528
    ds_read_b64_tr_b16 v[170:171], v246 offset:23808
    v_mfma_f32_16x16x32_bf16 v[44:47], v[128:131], v[124:127], v[44:47]
    v_mfma_f32_16x16x32_bf16 v[48:51], v[132:135], v[112:115], v[48:51]
    ds_read_b128 v[156:159], v242 offset:9216
    ds_read_b64_tr_b16 v[172:173], v245 offset:22592
    v_mfma_f32_16x16x32_bf16 v[52:55], v[132:135], v[116:119], v[52:55]
    ds_read_b64_tr_b16 v[174:175], v245 offset:23872
    v_mfma_f32_16x16x32_bf16 v[56:59], v[132:135], v[120:123], v[56:59]
    v_mfma_f32_16x16x32_bf16 v[60:63], v[132:135], v[124:127], v[60:63]
    v_mfma_f32_16x16x32_bf16 v[64:67], v[136:139], v[112:115], v[64:67]
    ds_read_b128 v[160:163], v242 offset:11264
    ds_read_b64_tr_b16 v[176:177], v246 offset:22592
    v_mfma_f32_16x16x32_bf16 v[68:71], v[136:139], v[116:119], v[68:71]
    s_waitcnt lgkmcnt(14)
    ds_read_b64_tr_b16 v[178:179], v246 offset:23872
    v_mfma_f32_16x16x32_bf16 v[72:75], v[136:139], v[120:123], v[72:75]
    s_waitcnt lgkmcnt(14)
    ds_read_b64_tr_b16 v[180:181], v245 offset:22656
    v_mfma_f32_16x16x32_bf16 v[76:79], v[136:139], v[124:127], v[76:79]
    s_waitcnt lgkmcnt(14)
    ds_read_b64_tr_b16 v[182:183], v245 offset:23936
    v_mfma_f32_16x16x32_bf16 v[80:83], v[140:143], v[112:115], v[80:83]
    s_waitcnt lgkmcnt(14)
    v_mfma_f32_16x16x32_bf16 v[84:87], v[140:143], v[116:119], v[84:87]
    v_mfma_f32_16x16x32_bf16 v[88:91], v[140:143], v[120:123], v[88:91]
    v_mfma_f32_16x16x32_bf16 v[92:95], v[140:143], v[124:127], v[92:95]
    v_mfma_f32_16x16x32_bf16 v[96:99], v[144:147], v[112:115], v[96:99]
    v_mfma_f32_16x16x32_bf16 v[100:103], v[144:147], v[116:119], v[100:103]
    v_mfma_f32_16x16x32_bf16 v[104:107], v[144:147], v[120:123], v[104:107]
    v_mfma_f32_16x16x32_bf16 v[108:111], v[144:147], v[124:127], v[108:111]
    s_waitcnt vmcnt(0)
    v_cmp_ne_u32 vcc, 1, v24
    s_cmp_lg_u64 vcc, 0
    s_cbranch_scc1 L_s_sl1
L_s_bk1:
    s_waitcnt lgkmcnt(0)
    s_barrier
    buffer_load_dword v23, v19, s[36:39], s13 offen sc1
    v_mfma_f32_16x16x32_bf16 v[32:35], v[164:167], v[148:151], v[32:35]
    ds_read_b128 v[112:115], v241 offset:36864
    ds_read_b64_tr_b16 v[128:129], v245 offset:40960
    v_mfma_f32_16x16x32_bf16 v[36:39], v[164:167], v[152:155], v[36:39]
    ds_read_b64_tr_b16 v[130:131], v245 offset:42240
    ds_read_b128 v[116:119], v241 offset:38912
    v_mfma_f32_16x16x32_bf16 v[40:43], v[164:167], v[156:159], v[40:43]
    ds_read_b64_tr_b16 v[132:133], v246 offset:40960
    ds_read_b64_tr_b16 v[134:135], v246 offset:42240
    v_mfma_f32_16x16x32_bf16 v[44:47], v[164:167], v[160:163], v[44:47]
    v_mfma_f32_16x16x32_bf16 v[48:51], v[168:171], v[148:151], v[48:51]
    ds_read_b128 v[120:123], v241 offset:46080
    ds_read_b64_tr_b16 v[136:137], v245 offset:41024
    v_mfma_f32_16x16x32_bf16 v[52:55], v[168:171], v[152:155], v[52:55]
    ds_read_b64_tr_b16 v[138:139], v245 offset:42304
    v_mfma_f32_16x16x32_bf16 v[56:59], v[168:171], v[156:159], v[56:59]
    v_mfma_f32_16x16x32_bf16 v[60:63], v[168:171], v[160:163], v[60:63]
    v_mfma_f32_16x16x32_bf16 v[64:67], v[172:175], v[148:151], v[64:67]
    ds_read_b128 v[124:127], v241 offset:48128
    ds_read_b64_tr_b16 v[140:141], v246 offset:41024
    v_mfma_f32_16x16x32_bf16 v[68:71], v[172:175], v[152:155], v[68:71]
    ds_read_b64_tr_b16 v[142:143], v246 offset:42304
    ds_read_b64_tr_b16 v[144:145], v245 offset:41088
    v_mfma_f32_16x16x32_bf16 v[72:75], v[172:175], v[156:159], v[72:75]
    ds_read_b64_tr_b16 v[146:147], v245 offset:42368
    v_mfma_f32_16x16x32_bf16 v[76:79], v[172:175], v[160:163], v[76:79]
    v_mfma_f32_16x16x32_bf16 v[80:83], v[176:179], v[148:151], v[80:83]
    v_mfma_f32_16x16x32_bf16 v[84:87], v[176:179], v[152:155], v[84:87]
    v_mfma_f32_16x16x32_bf16 v[88:91], v[176:179], v[156:159], v[88:91]
    v_mfma_f32_16x16x32_bf16 v[92:95], v[176:179], v[160:163], v[92:95]
    v_mfma_f32_16x16x32_bf16 v[96:99], v[180:183], v[148:151], v[96:99]
    v_mfma_f32_16x16x32_bf16 v[100:103], v[180:183], v[152:155], v[100:103]
    v_mfma_f32_16x16x32_bf16 v[104:107], v[180:183], v[156:159], v[104:107]
    v_mfma_f32_16x16x32_bf16 v[108:111], v[180:183], v[160:163], v[108:111]
    s_waitcnt lgkmcnt(4)
    v_mfma_f32_16x16x32_bf16 v[32:35], v[128:131], v[112:115], v[32:35]
    ds_read_b128 v[148:151], v242 offset:36864
    ds_read_b64_tr_b16 v[164:165], v245 offset:59392
    v_mfma_f32_16x16x32_bf16 v[36:39], v[128:131], v[116:119], v[36:39]
    ds_read_b64_tr_b16 v[166:167], v245 offset:60672
    ds_read_b128 v[152:155], v242 offset:38912
    v_mfma_f32_16x16x32_bf16 v[40:43], v[128:131], v[120:123], v[40:43]
    ds_read_b64_tr_b16 v[168:169], v246 offset:59392
    ds_read_b64_tr_b16 v[170:171], v246 offset:60672
    v_mfma_f32_16x16x32_bf16 v[44:47], v[128:131], v[124:127], v[44:47]
    v_mfma_f32_16x16x32_bf16 v[48:51], v[132:135], v[112:115], v[48:51]
    ds_read_b128 v[156:159], v242 offset:46080
    ds_read_b64_tr_b16 v[172:173], v245 offset:59456
    v_mfma_f32_16x16x32_bf16 v[52:55], v[132:135], v[116:119], v[52:55]
    ds_read_b64_tr_b16 v[174:175], v245 offset:60736
    v_mfma_f32_16x16x32_bf16 v[56:59], v[132:135], v[120:123], v[56:59]
    v_mfma_f32_16x16x32_bf16 v[60:63], v[132:135], v[124:127], v[60:63]
    v_mfma_f32_16x16x32_bf16 v[64:67], v[136:139], v[112:115], v[64:67]
    ds_read_b128 v[160:163], v242 offset:48128
    ds_read_b64_tr_b16 v[176:177], v246 offset:59456
    v_mfma_f32_16x16x32_bf16 v[68:71], v[136:139], v[116:119], v[68:71]
    s_waitcnt lgkmcnt(14)
    ds_read_b64_tr_b16 v[178:179], v246 offset:60736
    v_mfma_f32_16x16x32_bf16 v[72:75], v[136:139], v[120:123], v[72:75]
    s_waitcnt lgkmcnt(14)
    ds_read_b64_tr_b16 v[180:181], v245 offset:59520
    v_mfma_f32_16x16x32_bf16 v[76:79], v[136:139], v[124:127], v[76:79]
    s_waitcnt lgkmcnt(14)
    ds_read_b64_tr_b16 v[182:183], v245 offset:60800
    v_mfma_f32_16x16x32_bf16 v[80:83], v[140:143], v[112:115], v[80:83]
    s_waitcnt lgkmcnt(14)
    v_mfma_f32_16x16x32_bf16 v[84:87], v[140:143], v[116:119], v[84:87]
    v_mfma_f32_16x16x32_bf16 v[88:91], v[140:143], v[120:123], v[88:91]
    v_mfma_f32_16x16x32_bf16 v[92:95], v[140:143], v[124:127], v[92:95]
    v_mfma_f32_16x16x32_bf16 v[96:99], v[144:147], v[112:115], v[96:99]
    v_mfma_f32_16x16x32_bf16 v[100:103], v[144:147], v[116:119], v[100:103]
    v_mfma_f32_16x16x32_bf16 v[104:107], v[144:147], v[120:123], v[104:107]
    v_mfma_f32_16x16x32_bf16 v[108:111], v[144:147], v[124:127], v[108:111]
    s_waitcnt lgkmcnt(4)
    v_mfma_f32_16x16x32_bf16 v[32:35], v[164:167], v[148:151], v[32:35]
    v_mfma_f32_16x16x32_bf16 v[36:39], v[164:167], v[152:155], v[36:39]
    v_mfma_f32_16x16x32_bf16 v[40:43], v[164:167], v[156:159], v[40:43]
    v_cvt_pk_bf16_f32 v112, v32, v33
    v_cvt_pk_bf16_f32 v113, v34, v35
    v_mfma_f32_16x16x32_bf16 v[44:47], v[164:167], v[160:163], v[44:47]
    v_cvt_pk_bf16_f32 v114, v36, v37
    v_cvt_pk_bf16_f32 v115, v38, v39
    v_mfma_f32_16x16x32_bf16 v[48:51], v[168:171], v[148:151], v[48:51]
    v_cvt_pk_bf16_f32 v116, v40, v41
    v_cvt_pk_bf16_f32 v117, v42, v43
    v_mfma_f32_16x16x32_bf16 v[52:55], v[168:171], v[152:155], v[52:55]
    v_cvt_pk_bf16_f32 v118, v44, v45
    v_cvt_pk_bf16_f32 v119, v46, v47
    v_mfma_f32_16x16x32_bf16 v[56:59], v[168:171], v[156:159], v[56:59]
    v_permlane16_swap_b32 v112, v114
    v_permlane16_swap_b32 v113, v115
    v_mfma_f32_16x16x32_bf16 v[60:63], v[168:171], v[160:163], v[60:63]
    v_permlane16_swap_b32 v116, v118
    v_permlane16_swap_b32 v117, v119
    buffer_store_dwordx4 v[112:115], v249, s[36:39], s8 offen offset:0 sc1
    buffer_store_dwordx4 v[116:119], v250, s[36:39], s8 offen offset:0 sc1
    v_mfma_f32_16x16x32_bf16 v[64:67], v[172:175], v[148:151], v[64:67]
    v_cvt_pk_bf16_f32 v120, v48, v49
    v_cvt_pk_bf16_f32 v121, v50, v51
    v_mfma_f32_16x16x32_bf16 v[68:71], v[172:175], v[152:155], v[68:71]
    v_cvt_pk_bf16_f32 v122, v52, v53
    v_cvt_pk_bf16_f32 v123, v54, v55
    v_mfma_f32_16x16x32_bf16 v[72:75], v[172:175], v[156:159], v[72:75]
    v_cvt_pk_bf16_f32 v124, v56, v57
    v_cvt_pk_bf16_f32 v125, v58, v59
    v_mfma_f32_16x16x32_bf16 v[76:79], v[172:175], v[160:163], v[76:79]
    v_cvt_pk_bf16_f32 v126, v60, v61
    v_cvt_pk_bf16_f32 v127, v62, v63
    v_permlane16_swap_b32 v120, v122
    v_permlane16_swap_b32 v121, v123
    v_permlane16_swap_b32 v124, v126
    v_permlane16_swap_b32 v125, v127
    buffer_store_dwordx4 v[120:123], v249, s[36:39], s9 offen offset:0 sc1
    buffer_store_dwordx4 v[124:127], v250, s[36:39], s9 offen offset:0 sc1
    s_waitcnt lgkmcnt(2)
    v_mfma_f32_16x16x32_bf16 v[80:83], v[176:179], v[148:151], v[80:83]
    v_cvt_pk_bf16_f32 v128, v64, v65
    v_cvt_pk_bf16_f32 v129, v66, v67
    v_mfma_f32_16x16x32_bf16 v[84:87], v[176:179], v[152:155], v[84:87]
    v_cvt_pk_bf16_f32 v130, v68, v69
    v_cvt_pk_bf16_f32 v131, v70, v71
    v_mfma_f32_16x16x32_bf16 v[88:91], v[176:179], v[156:159], v[88:91]
    v_cvt_pk_bf16_f32 v132, v72, v73
    v_cvt_pk_bf16_f32 v133, v74, v75
    v_mfma_f32_16x16x32_bf16 v[92:95], v[176:179], v[160:163], v[92:95]
    v_cvt_pk_bf16_f32 v134, v76, v77
    v_cvt_pk_bf16_f32 v135, v78, v79
    v_permlane16_swap_b32 v128, v130
    v_permlane16_swap_b32 v129, v131
    v_permlane16_swap_b32 v132, v134
    v_permlane16_swap_b32 v133, v135
    buffer_store_dwordx4 v[128:131], v249, s[36:39], s8 offen offset:1024 sc1
    buffer_store_dwordx4 v[132:135], v250, s[36:39], s8 offen offset:1024 sc1
    s_waitcnt lgkmcnt(0)
    v_mfma_f32_16x16x32_bf16 v[96:99], v[180:183], v[148:151], v[96:99]
    v_cvt_pk_bf16_f32 v136, v80, v81
    v_cvt_pk_bf16_f32 v137, v82, v83
    v_mfma_f32_16x16x32_bf16 v[100:103], v[180:183], v[152:155], v[100:103]
    v_cvt_pk_bf16_f32 v138, v84, v85
    v_cvt_pk_bf16_f32 v139, v86, v87
    v_mfma_f32_16x16x32_bf16 v[104:107], v[180:183], v[156:159], v[104:107]
    v_cvt_pk_bf16_f32 v140, v88, v89
    v_cvt_pk_bf16_f32 v141, v90, v91
    v_mfma_f32_16x16x32_bf16 v[108:111], v[180:183], v[160:163], v[108:111]
    v_cvt_pk_bf16_f32 v142, v92, v93
    v_cvt_pk_bf16_f32 v143, v94, v95
    v_permlane16_swap_b32 v136, v138
    v_permlane16_swap_b32 v137, v139
    v_permlane16_swap_b32 v140, v142
    v_permlane16_swap_b32 v141, v143
    buffer_store_dwordx4 v[136:139], v249, s[36:39], s9 offen offset:1024 sc1
    buffer_store_dwordx4 v[140:143], v250, s[36:39], s9 offen offset:1024 sc1
    v_cvt_pk_bf16_f32 v112, v96, v97
    v_cvt_pk_bf16_f32 v113, v98, v99
    v_cvt_pk_bf16_f32 v114, v100, v101
    v_cvt_pk_bf16_f32 v115, v102, v103
    v_cvt_pk_bf16_f32 v116, v104, v105
    v_cvt_pk_bf16_f32 v117, v106, v107
    v_cvt_pk_bf16_f32 v118, v108, v109
    v_cvt_pk_bf16_f32 v119, v110, v111
    v_permlane16_swap_b32 v112, v114
    v_permlane16_swap_b32 v113, v115
    v_permlane16_swap_b32 v116, v118
    v_permlane16_swap_b32 v117, v119
    buffer_store_dwordx4 v[112:115], v249, s[36:39], s8 offen offset:2048 sc1
    buffer_store_dwordx4 v[116:119], v250, s[36:39], s8 offen offset:2048 sc1
    s_waitcnt vmcnt(10)
    v_cmp_ne_u32 vcc, 1, v23
    s_cmp_lg_u64 vcc, 0
    s_cbranch_scc1 L_s_sl2
L_s_bk2:
    s_barrier
    s_waitcnt vmcnt(0)
    s_mov_b64 exec, 1
    buffer_store_dword v20, v4, s[36:39], s10 offen sc1
    s_mov_b64 exec, -1
    s_waitcnt vmcnt(0)
    buffer_load_dword v22, v17, s[36:39], s14 offen sc1
    s_waitcnt vmcnt(0)
    v_cmp_ne_u32 vcc, 1, v22
    s_cmp_lg_u64 vcc, 0
    s_cbranch_scc1 L_s_sl3
L_s_bk3:
    buffer_load_dwordx4 a[0:3], v5, s[36:39], s57 offen offset:0 sc1
    buffer_load_dwordx4 a[4:7], v6, s[36:39], s57 offen offset:0 sc1
    buffer_load_dwordx4 a[8:11], v5, s[36:39], s57 offen offset:1024 sc1
    buffer_load_dwordx4 a[12:15], v6, s[36:39], s57 offen offset:1024 sc1
    buffer_load_dwordx4 a[16:19], v5, s[36:39], s58 offen offset:0 sc1
    buffer_load_dwordx4 a[20:23], v6, s[36:39], s58 offen offset:0 sc1
    buffer_load_dwordx4 a[24:27], v5, s[36:39], s58 offen offset:1024 sc1
    buffer_load_dwordx4 a[28:31], v6, s[36:39], s58 offen offset:1024 sc1
    buffer_load_dwordx4 a[32:35], v5, s[36:39], s59 offen offset:0 sc1
    buffer_load_dwordx4 a[36:39], v6, s[36:39], s59 offen offset:0 sc1
    buffer_load_dwordx4 a[40:43], v5, s[36:39], s59 offen offset:1024 sc1
    buffer_load_dwordx4 a[44:47], v6, s[36:39], s59 offen offset:1024 sc1
    buffer_load_dwordx4 a[48:51], v5, s[36:39], s60 offen offset:0 sc1
    buffer_load_dwordx4 a[52:55], v6, s[36:39], s60 offen offset:0 sc1
    buffer_load_dwordx4 a[56:59], v5, s[36:39], s60 offen offset:1024 sc1
    buffer_load_dwordx4 a[60:63], v6, s[36:39], s60 offen offset:1024 sc1
    buffer_load_dwordx4 a[64:67], v5, s[36:39], s61 offen offset:0 sc1
    buffer_load_dwordx4 a[68:71], v6, s[36:39], s61 offen offset:0 sc1
    buffer_load_dwordx4 a[72:75], v5, s[36:39], s61 offen offset:1024 sc1
    buffer_load_dwordx4 a[76:79], v6, s[36:39], s61 offen offset:1024 sc1
    buffer_load_dwordx4 a[80:83], v5, s[36:39], s62 offen offset:0 sc1
    buffer_load_dwordx4 a[84:87], v6, s[36:39], s62 offen offset:0 sc1
    buffer_load_dwordx4 a[88:91], v5, s[36:39], s62 offen offset:1024 sc1
    buffer_load_dwordx4 a[92:95], v6, s[36:39], s62 offen offset:1024 sc1
    buffer_load_dwordx4 a[96:99], v5, s[36:39], s63 offen offset:0 sc1
    buffer_load_dwordx4 a[100:103], v6, s[36:39], s63 offen offset:0 sc1
    buffer_load_dwordx4 a[104:107], v5, s[36:39], s63 offen offset:1024 sc1
    s_add_u32 m0, s22, 0
    buffer_load_dwordx4 v9, s[36:39], s57 offen offset:0 sc1 lds
    buffer_load_dwordx4 v10, s[36:39], s57 offen offset:1024 sc1 lds
    buffer_load_dwordx4 v11, s[36:39], s57 offen offset:2048 sc1 lds
    s_add_u32 m0, s22, 12288
    buffer_load_dwordx4 v9, s[36:39], s58 offen offset:0 sc1 lds
    buffer_load_dwordx4 v10, s[36:39], s58 offen offset:1024 sc1 lds
    buffer_load_dwordx4 v11, s[36:39], s58 offen offset:2048 sc1 lds
    s_add_u32 m0, s22, 24576
    buffer_load_dwordx4 v9, s[36:39], s59 offen offset:0 sc1 lds
    buffer_load_dwordx4 v10, s[36:39], s59 offen offset:1024 sc1 lds
    buffer_load_dwordx4 v11, s[36:39], s59 offen offset:2048 sc1 lds
    s_add_u32 m0, s22, 36864
    buffer_load_dwordx4 v9, s[36:39], s60 offen offset:0 sc1 lds
    buffer_load_dwordx4 v10, s[36:39], s60 offen offset:1024 sc1 lds
    buffer_load_dwordx4 v11, s[36:39], s60 offen offset:2048 sc1 lds
    buffer_load_dwordx4 a[108:111], v6, s[36:39], s63 offen offset:1024 sc1
    s_waitcnt vmcnt(10)
    ds_read_b128 v[32:35], v13 offset:0
    ds_read_b128 v[36:39], v13 offset:1024
    ds_read_b128 v[40:43], v13 offset:2048
    buffer_load_dwordx4 a[112:115], v5, s[36:39], s64 offen offset:0 sc1
    s_add_u32 m0, s22, 49152
    buffer_load_dwordx4 v9, s[36:39], s61 offen offset:0 sc1 lds
    s_waitcnt lgkmcnt(0)
    v_max3_u32 v44, v32, v34, v36
    v_max3_u32 v38, v38, v40, v42
    buffer_load_dwordx4 v10, s[36:39], s61 offen offset:1024 sc1 lds
    v_max_u32 v44, v44, v38
    v_cmp_eq_u32 vcc, -1, v44
    s_cbranch_vccnz L_s_gs0
L_s_gb0:
    s_barrier
    ds_read_b128 v[176:179], v12 offset:0
    ds_read_b128 v[180:183], v12 offset:1024
    ds_read_b128 v[184:187], v12 offset:2048
    ds_read_b128 v[188:191], v12 offset:3072
    ds_read_b128 v[192:195], v12 offset:4096
    s_waitcnt vmcnt(10)
    ds_read_b128 v[32:35], v13 offset:12288
    ds_read_b128 v[36:39], v13 offset:13312
    ds_read_b128 v[196:199], v12 offset:5120
    ds_read_b128 v[200:203], v12 offset:6144
    ds_read_b128 v[204:207], v12 offset:7168
    ds_read_b128 v[40:43], v13 offset:14336
    buffer_load_dwordx4 v11, s[36:39], s61 offen offset:2048 sc1 lds
    s_add_u32 m0, s22, 61440
    buffer_load_dwordx4 v9, s[36:39], s62 offen offset:0 sc1 lds
    s_waitcnt lgkmcnt(10)
    v_mfma_f32_16x16x32_bf16 v[208:211], v[176:179], a[0:3], 0
    v_mfma_f32_16x16x32_bf16 v[212:215], v[176:179], a[4:7], 0
    ds_read_b128 v[176:179], v12 offset:8192
    s_waitcnt lgkmcnt(9)
    v_mfma_f32_16x16x32_bf16 v[216:219], v[180:183], a[0:3], 0
    v_mfma_f32_16x16x32_bf16 v[220:223], v[180:183], a[4:7], 0
    ds_read_b128 v[180:183], v12 offset:9216
    buffer_load_dwordx4 v10, s[36:39], s62 offen offset:1024 sc1 lds
    v_mfma_f32_16x16x32_bf16 v[224:227], v[184:187], a[0:3], 0
    v_mfma_f32_16x16x32_bf16 v[228:231], v[184:187], a[4:7], 0
    ds_read_b128 v[184:187], v12 offset:10240
    s_waitcnt lgkmcnt(7)
    v_mfma_f32_16x16x32_bf16 v[232:235], v[188:191], a[0:3], 0
    v_mfma_f32_16x16x32_bf16 v[236:239], v[188:191], a[4:7], 0
    ds_read_b128 v[188:191], v12 offset:11264
    buffer_load_dwordx4 v11, s[36:39], s62 offen offset:2048 sc1 lds
    v_mfma_f32_16x16x32_bf16 v[240:243], v[192:195], a[0:3], 0
    s_waitcnt lgkmcnt(4)
    v_max3_u32 v44, v32, v34, v36
    v_mfma_f32_16x16x32_bf16 v[244:247], v[192:195], a[4:7], 0
    v_max3_u32 v38, v38, v40, v42
    v_mfma_f32_16x16x32_bf16 v[248:251], v[196:199], a[0:3], 0
    v_max_u32 v44, v44, v38
    v_mfma_f32_16x16x32_bf16 v[252:255], v[196:199], a[4:7], 0
    v_cmp_eq_u32 vcc, -1, v44
    buffer_load_dwordx4 a[116:119], v6, s[36:39], s64 offen offset:0 sc1
    v_mfma_f32_16x16x32_bf16 v[208:211], v[200:203], a[8:11], v[208:211]
    s_cbranch_vccnz L_s_gs1
L_s_gb1:
    s_barrier
    v_mfma_f32_16x16x32_bf16 v[212:215], v[200:203], a[12:15], v[212:215]
    ds_read_b128 v[192:195], v12 offset:12288
    ds_read_b128 v[196:199], v12 offset:13312
    v_mfma_f32_16x16x32_bf16 v[216:219], v[204:207], a[8:11], v[216:219]
    ds_read_b128 v[200:203], v12 offset:14336
    s_waitcnt vmcnt(12)
    ds_read_b128 v[32:35], v13 offset:24576
    v_mfma_f32_16x16x32_bf16 v[220:223], v[204:207], a[12:15], v[220:223]
    ds_read_b128 v[204:207], v12 offset:15360
    ds_read_b128 v[36:39], v13 offset:25600
    s_waitcnt lgkmcnt(6)
    v_mfma_f32_16x16x32_bf16 v[224:227], v[176:179], a[8:11], v[224:227]
    ds_read_b128 v[40:43], v13 offset:26624
    buffer_load_dwordx4 a[120:123], v5, s[36:39], s64 offen offset:1024 sc1
    v_mfma_f32_16x16x32_bf16 v[228:231], v[176:179], a[12:15], v[228:231]
    ds_read_b128 v[176:179], v12 offset:16384
    v_mfma_f32_16x16x32_bf16 v[232:235], v[180:183], a[8:11], v[232:235]
    buffer_load_dwordx4 a[124:127], v6, s[36:39], s64 offen offset:1024 sc1
    v_mfma_f32_16x16x32_bf16 v[236:239], v[180:183], a[12:15], v[236:239]
    ds_read_b128 v[180:183], v12 offset:17408
    v_mfma_f32_16x16x32_bf16 v[240:243], v[184:187], a[8:11], v[240:243]
    v_mfma_f32_16x16x32_bf16 v[244:247], v[184:187], a[12:15], v[244:247]
    ds_read_b128 v[184:187], v12 offset:18432
    v_mfma_f32_16x16x32_bf16 v[248:251], v[188:191], a[8:11], v[248:251]
    buffer_load_dwordx4 a[128:131], v5, s[36:39], s65 offen offset:0 sc1
    v_mfma_f32_16x16x32_bf16 v[252:255], v[188:191], a[12:15], v[252:255]
    ds_read_b128 v[188:191], v12 offset:19456
    s_waitcnt lgkmcnt(5)
    v_mfma_f32_16x16x32_bf16 v[208:211], v[192:195], a[16:19], v[208:211]
    s_waitcnt lgkmcnt(4)
    v_max3_u32 v44, v32, v34, v36
    v_mfma_f32_16x16x32_bf16 v[212:215], v[192:195], a[20:23], v[212:215]
    ds_read_b128 v[192:195], v12 offset:20480
    v_max3_u32 v38, v38, v40, v42
    v_mfma_f32_16x16x32_bf16 v[216:219], v[196:199], a[16:19], v[216:219]
    v_max_u32 v44, v44, v38
    buffer_load_dwordx4 a[132:135], v6, s[36:39], s65 offen offset:0 sc1
    v_mfma_f32_16x16x32_bf16 v[220:223], v[196:199], a[20:23], v[220:223]
    ds_read_b128 v[196:199], v12 offset:21504
    v_cmp_eq_u32 vcc, -1, v44
    v_mfma_f32_16x16x32_bf16 v[224:227], v[200:203], a[16:19], v[224:227]
    s_cbranch_vccnz L_s_gs2
L_s_gb2:
    s_barrier
    v_mfma_f32_16x16x32_bf16 v[228:231], v[200:203], a[20:23], v[228:231]
    ds_read_b128 v[200:203], v12 offset:22528
    s_waitcnt vmcnt(13)
    ds_read_b128 v[32:35], v13 offset:36864
    v_mfma_f32_16x16x32_bf16 v[232:235], v[204:207], a[16:19], v[232:235]
    ds_read_b128 v[36:39], v13 offset:37888
    ds_read_b128 v[40:43], v13 offset:38912
    v_mfma_f32_16x16x32_bf16 v[236:239], v[204:207], a[20:23], v[236:239]
    ds_read_b128 v[204:207], v12 offset:23552
    buffer_load_dwordx4 a[136:139], v5, s[36:39], s65 offen offset:1024 sc1
    s_waitcnt lgkmcnt(6)
    v_mfma_f32_16x16x32_bf16 v[240:243], v[176:179], a[16:19], v[240:243]
    v_mfma_f32_16x16x32_bf16 v[244:247], v[176:179], a[20:23], v[244:247]
    ds_read_b128 v[176:179], v12 offset:24576
    v_mfma_f32_16x16x32_bf16 v[248:251], v[180:183], a[16:19], v[248:251]
    buffer_load_dwordx4 a[140:143], v6, s[36:39], s65 offen offset:1024 sc1
    v_mfma_f32_16x16x32_bf16 v[252:255], v[180:183], a[20:23], v[252:255]
    ds_read_b128 v[180:183], v12 offset:25600
    v_mfma_f32_16x16x32_bf16 v[208:211], v[184:187], a[24:27], v[208:211]
    v_mfma_f32_16x16x32_bf16 v[212:215], v[184:187], a[28:31], v[212:215]
    ds_read_b128 v[184:187], v12 offset:26624
    v_mfma_f32_16x16x32_bf16 v[216:219], v[188:191], a[24:27], v[216:219]
    s_waitcnt lgkmcnt(4)
    v_max3_u32 v44, v32, v34, v36
    v_mfma_f32_16x16x32_bf16 v[220:223], v[188:191], a[28:31], v[220:223]
    ds_read_b128 v[188:191], v12 offset:27648
    v_max3_u32 v38, v38, v40, v42
    v_mfma_f32_16x16x32_bf16 v[224:227], v[192:195], a[24:27], v[224:227]
    v_max_u32 v44, v44, v38
    buffer_load_dwordx4 a[144:147], v5, s[36:39], s66 offen offset:0 sc1
    v_mfma_f32_16x16x32_bf16 v[228:231], v[192:195], a[28:31], v[228:231]
    ds_read_b128 v[192:195], v12 offset:28672
    v_cmp_eq_u32 vcc, -1, v44
    v_mfma_f32_16x16x32_bf16 v[232:235], v[196:199], a[24:27], v[232:235]
    s_cbranch_vccnz L_s_gs3
L_s_gb3:
    s_barrier
    v_mfma_f32_16x16x32_bf16 v[236:239], v[196:199], a[28:31], v[236:239]
    ds_read_b128 v[196:199], v12 offset:29696
    s_waitcnt vmcnt(11)
    ds_read_b128 v[32:35], v13 offset:49152
    v_mfma_f32_16x16x32_bf16 v[240:243], v[200:203], a[24:27], v[240:243]
    ds_read_b128 v[36:39], v13 offset:50176
    ds_read_b128 v[40:43], v13 offset:51200
    v_mfma_f32_16x16x32_bf16 v[244:247], v[200:203], a[28:31], v[244:247]
    ds_read_b128 v[200:203], v12 offset:30720
    buffer_load_dwordx4 a[148:151], v6, s[36:39], s66 offen offset:0 sc1
    s_waitcnt lgkmcnt(6)
    v_mfma_f32_16x16x32_bf16 v[248:251], v[204:207], a[24:27], v[248:251]
    buffer_load_dwordx4 a[152:155], v5, s[36:39], s66 offen offset:1024 sc1
    v_mfma_f32_16x16x32_bf16 v[252:255], v[204:207], a[28:31], v[252:255]
    ds_read_b128 v[204:207], v12 offset:31744
    v_mfma_f32_16x16x32_bf16 v[208:211], v[176:179], a[32:35], v[208:211]
    v_mfma_f32_16x16x32_bf16 v[212:215], v[176:179], a[36:39], v[212:215]
    ds_read_b128 v[176:179], v12 offset:32768
    buffer_load_dwordx4 a[156:159], v6, s[36:39], s66 offen offset:1024 sc1
    v_mfma_f32_16x16x32_bf16 v[216:219], v[180:183], a[32:35], v[216:219]
    s_add_u32 m0, s22, 73728
    v_mfma_f32_16x16x32_bf16 v[220:223], v[180:183], a[36:39], v[220:223]
    ds_read_b128 v[180:183], v12 offset:33792
    s_waitcnt lgkmcnt(4)
    v_max3_u32 v44, v32, v34, v36
    v_mfma_f32_16x16x32_bf16 v[224:227], v[184:187], a[32:35], v[224:227]
    v_max3_u32 v38, v38, v40, v42
    v_mfma_f32_16x16x32_bf16 v[228:231], v[184:187], a[36:39], v[228:231]
    ds_read_b128 v[184:187], v12 offset:34816
    v_max_u32 v44, v44, v38
    v_mfma_f32_16x16x32_bf16 v[232:235], v[188:191], a[32:35], v[232:235]
    v_cmp_eq_u32 vcc, -1, v44
    buffer_load_dwordx4 v9, s[36:39], s63 offen offset:0 sc1 lds
    v_mfma_f32_16x16x32_bf16 v[236:239], v[188:191], a[36:39], v[236:239]
    ds_read_b128 v[188:191], v12 offset:35840
    v_mfma_f32_16x16x32_bf16 v[240:243], v[192:195], a[32:35], v[240:243]
    s_cbranch_vccnz L_s_gs4
L_s_gb4:
    s_barrier
    v_mfma_f32_16x16x32_bf16 v[244:247], v[192:195], a[36:39], v[244:247]
    ds_read_b128 v[192:195], v12 offset:36864
    s_waitcnt vmcnt(12)
    ds_read_b128 v[32:35], v14 offset:0
    v_mfma_f32_16x16x32_bf16 v[248:251], v[196:199], a[32:35], v[248:251]
    ds_read_b128 v[36:39], v14 offset:1024
    ds_read_b128 v[40:43], v14 offset:2048
    v_mfma_f32_16x16x32_bf16 v[252:255], v[196:199], a[36:39], v[252:255]
    ds_read_b128 v[196:199], v12 offset:37888
    buffer_load_dwordx4 v10, s[36:39], s63 offen offset:1024 sc1 lds
    s_waitcnt lgkmcnt(6)
    v_mfma_f32_16x16x32_bf16 v[208:211], v[200:203], a[40:43], v[208:211]
    buffer_load_dwordx4 v11, s[36:39], s63 offen offset:2048 sc1 lds
    s_add_u32 m0, s22, 86016
    v_mfma_f32_16x16x32_bf16 v[212:215], v[200:203], a[44:47], v[212:215]
    ds_read_b128 v[200:203], v12 offset:38912
    v_mfma_f32_16x16x32_bf16 v[216:219], v[204:207], a[40:43], v[216:219]
    v_mfma_f32_16x16x32_bf16 v[220:223], v[204:207], a[44:47], v[220:223]
    ds_read_b128 v[204:207], v12 offset:39936
    v_mfma_f32_16x16x32_bf16 v[224:227], v[176:179], a[40:43], v[224:227]
    buffer_load_dwordx4 v9, s[36:39], s64 offen offset:0 sc1 lds
    v_mfma_f32_16x16x32_bf16 v[228:231], v[176:179], a[44:47], v[228:231]
    ds_read_b128 v[176:179], v12 offset:40960
    s_waitcnt lgkmcnt(4)
    v_max3_u32 v44, v32, v34, v36
    v_mfma_f32_16x16x32_bf16 v[232:235], v[180:183], a[40:43], v[232:235]
    v_max3_u32 v38, v38, v40, v42
    v_mfma_f32_16x16x32_bf16 v[236:239], v[180:183], a[44:47], v[236:239]
    ds_read_b128 v[180:183], v12 offset:41984
    v_max_u32 v44, v44, v38
    v_mfma_f32_16x16x32_bf16 v[240:243], v[184:187], a[40:43], v[240:243]
    v_cmp_eq_u32 vcc, -1, v44
    buffer_load_dwordx4 v10, s[36:39], s64 offen offset:1024 sc1 lds
    v_mfma_f32_16x16x32_bf16 v[244:247], v[184:187], a[44:47], v[244:247]
    ds_read_b128 v[184:187], v12 offset:43008
    v_mfma_f32_16x16x32_bf16 v[248:251], v[188:191], a[40:43], v[248:251]
    s_cbranch_vccnz L_s_gs5
L_s_gb5:
    s_barrier
    v_mfma_f32_16x16x32_bf16 v[252:255], v[188:191], a[44:47], v[252:255]
    ds_read_b128 v[188:191], v12 offset:44032
    v_mfma_f32_16x16x32_bf16 v[208:211], v[192:195], a[48:51], v[208:211]
    buffer_load_dwordx4 v11, s[36:39], s64 offen offset:2048 sc1 lds
    v_mfma_f32_16x16x32_bf16 v[212:215], v[192:195], a[52:55], v[212:215]
    ds_read_b128 v[192:195], v12 offset:45056
    s_waitcnt lgkmcnt(3)
    v_mfma_f32_16x16x32_bf16 v[216:219], v[196:199], a[48:51], v[216:219]
    v_mfma_f32_16x16x32_bf16 v[220:223], v[196:199], a[52:55], v[220:223]
    ds_read_b128 v[196:199], v12 offset:46080
    v_mfma_f32_16x16x32_bf16 v[224:227], v[200:203], a[48:51], v[224:227]
    v_mfma_f32_16x16x32_bf16 v[228:231], v[200:203], a[52:55], v[228:231]
    ds_read_b128 v[200:203], v12 offset:47104
    v_mfma_f32_16x16x32_bf16 v[232:235], v[204:207], a[48:51], v[232:235]
    v_mfma_f32_16x16x32_bf16 v[236:239], v[204:207], a[52:55], v[236:239]
    ds_read_b128 v[204:207], v12 offset:48128
    v_mfma_f32_16x16x32_bf16 v[240:243], v[176:179], a[48:51], v[240:243]
    v_mfma_f32_16x16x32_bf16 v[244:247], v[176:179], a[52:55], v[244:247]
    ds_read_b128 v[176:179], v12 offset:49152
    v_mfma_f32_16x16x32_bf16 v[248:251], v[180:183], a[48:51], v[248:251]
    v_mfma_f32_16x16x32_bf16 v[252:255], v[180:183], a[52:55], v[252:255]
    ds_read_b128 v[180:183], v12 offset:50176
    s_waitcnt lgkmcnt(4)
    v_mfma_f32_16x16x32_bf16 v[208:211], v[184:187], a[56:59], v[208:211]
    v_mfma_f32_16x16x32_bf16 v[212:215], v[184:187], a[60:63], v[212:215]
    ds_read_b128 v[184:187], v12 offset:51200
    v_mfma_f32_16x16x32_bf16 v[216:219], v[188:191], a[56:59], v[216:219]
    v_mfma_f32_16x16x32_bf16 v[220:223], v[188:191], a[60:63], v[220:223]
    ds_read_b128 v[188:191], v12 offset:52224
    v_mfma_f32_16x16x32_bf16 v[224:227], v[192:195], a[56:59], v[224:227]
    v_mfma_f32_16x16x32_bf16 v[228:231], v[192:195], a[60:63], v[228:231]
    ds_read_b128 v[192:195], v12 offset:53248
    v_mfma_f32_16x16x32_bf16 v[232:235], v[196:199], a[56:59], v[232:235]
    v_mfma_f32_16x16x32_bf16 v[236:239], v[196:199], a[60:63], v[236:239]
    ds_read_b128 v[196:199], v12 offset:54272
    s_waitcnt lgkmcnt(4)
    v_mfma_f32_16x16x32_bf16 v[240:243], v[200:203], a[56:59], v[240:243]
    v_mfma_f32_16x16x32_bf16 v[244:247], v[200:203], a[60:63], v[244:247]
    ds_read_b128 v[200:203], v12 offset:55296
    v_mfma_f32_16x16x32_bf16 v[248:251], v[204:207], a[56:59], v[248:251]
    v_mfma_f32_16x16x32_bf16 v[252:255], v[204:207], a[60:63], v[252:255]
    ds_read_b128 v[204:207], v12 offset:56320
    v_mfma_f32_16x16x32_bf16 v[208:211], v[176:179], a[64:67], v[208:211]
    v_mfma_f32_16x16x32_bf16 v[212:215], v[176:179], a[68:71], v[212:215]
    ds_read_b128 v[176:179], v12 offset:57344
    v_mfma_f32_16x16x32_bf16 v[216:219], v[180:183], a[64:67], v[216:219]
    v_mfma_f32_16x16x32_bf16 v[220:223], v[180:183], a[68:71], v[220:223]
    ds_read_b128 v[180:183], v12 offset:58368
    s_waitcnt lgkmcnt(4)
    v_mfma_f32_16x16x32_bf16 v[224:227], v[184:187], a[64:67], v[224:227]
    v_mfma_f32_16x16x32_bf16 v[228:231], v[184:187], a[68:71], v[228:231]
    ds_read_b128 v[184:187], v12 offset:59392
    v_mfma_f32_16x16x32_bf16 v[232:235], v[188:191], a[64:67], v[232:235]
    v_mfma_f32_16x16x32_bf16 v[236:239], v[188:191], a[68:71], v[236:239]
    ds_read_b128 v[188:191], v12 offset:60416
    v_mfma_f32_16x16x32_bf16 v[240:243], v[192:195], a[64:67], v[240:243]
    v_mfma_f32_16x16x32_bf16 v[244:247], v[192:195], a[68:71], v[244:247]
    ds_read_b128 v[192:195], v0 offset:0
    v_mfma_f32_16x16x32_bf16 v[248:251], v[196:199], a[64:67], v[248:251]
    v_mfma_f32_16x16x32_bf16 v[252:255], v[196:199], a[68:71], v[252:255]
    ds_read_b128 v[196:199], v0 offset:1024
    s_waitcnt vmcnt(3)
    ds_read_b128 v[32:35], v14 offset:12288
    s_waitcnt lgkmcnt(4)
    v_mfma_f32_16x16x32_bf16 v[208:211], v[200:203], a[72:75], v[208:211]
    ds_read_b128 v[36:39], v14 offset:13312
    ds_read_b128 v[40:43], v14 offset:14336
    v_mfma_f32_16x16x32_bf16 v[212:215], v[200:203], a[76:79], v[212:215]
    ds_read_b128 v[200:203], v0 offset:2048
    v_mfma_f32_16x16x32_bf16 v[216:219], v[204:207], a[72:75], v[216:219]
    v_mfma_f32_16x16x32_bf16 v[220:223], v[204:207], a[76:79], v[220:223]
    ds_read_b128 v[204:207], v0 offset:3072
    v_mfma_f32_16x16x32_bf16 v[224:227], v[176:179], a[72:75], v[224:227]
    v_mfma_f32_16x16x32_bf16 v[228:231], v[176:179], a[76:79], v[228:231]
    ds_read_b128 v[176:179], v0 offset:4096
    v_mfma_f32_16x16x32_bf16 v[232:235], v[180:183], a[72:75], v[232:235]
    v_mfma_f32_16x16x32_bf16 v[236:239], v[180:183], a[76:79], v[236:239]
    ds_read_b128 v[180:183], v0 offset:5120
    v_mfma_f32_16x16x32_bf16 v[240:243], v[184:187], a[72:75], v[240:243]
    s_waitcnt lgkmcnt(4)
    v_max3_u32 v44, v32, v34, v36
    v_mfma_f32_16x16x32_bf16 v[244:247], v[184:187], a[76:79], v[244:247]
    ds_read_b128 v[184:187], v0 offset:6144
    v_max3_u32 v38, v38, v40, v42
    v_mfma_f32_16x16x32_bf16 v[248:251], v[188:191], a[72:75], v[248:251]
    v_max_u32 v44, v44, v38
    v_mfma_f32_16x16x32_bf16 v[252:255], v[188:191], a[76:79], v[252:255]
    ds_read_b128 v[188:191], v0 offset:7168
    v_cmp_eq_u32 vcc, -1, v44
    v_mfma_f32_16x16x32_bf16 v[208:211], v[192:195], a[80:83], v[208:211]
    s_cbranch_vccnz L_s_gs6
L_s_gb6:
    s_barrier
    v_mfma_f32_16x16x32_bf16 v[212:215], v[192:195], a[84:87], v[212:215]
    ds_read_b128 v[192:195], v0 offset:8192
    s_waitcnt vmcnt(0)
    ds_read_b128 v[32:35], v14 offset:24576
    v_mfma_f32_16x16x32_bf16 v[216:219], v[196:199], a[80:83], v[216:219]
    ds_read_b128 v[36:39], v14 offset:25600
    ds_read_b128 v[40:43], v14 offset:26624
    v_mfma_f32_16x16x32_bf16 v[220:223], v[196:199], a[84:87], v[220:223]
    ds_read_b128 v[196:199], v0 offset:9216
    s_waitcnt lgkmcnt(6)
    v_mfma_f32_16x16x32_bf16 v[224:227], v[200:203], a[80:83], v[224:227]
    v_mfma_f32_16x16x32_bf16 v[228:231], v[200:203], a[84:87], v[228:231]
    ds_read_b128 v[200:203], v0 offset:10240
    v_mfma_f32_16x16x32_bf16 v[232:235], v[204:207], a[80:83], v[232:235]
    s_add_u32 m0, s22, 98304
    v_mfma_f32_16x16x32_bf16 v[236:239], v[204:207], a[84:87], v[236:239]
    buffer_load_dwordx4 v9, s[36:39], s65 offen offset:0 sc1 lds
    buffer_load_dwordx4 v10, s[36:39], s65 offen offset:1024 sc1 lds
    buffer_load_dwordx4 v11, s[36:39], s65 offen offset:2048 sc1 lds
    s_add_u32 m0, s22, 110592
    v_mfma_f32_16x16x32_bf16 v[240:243], v[176:179], a[80:83], v[240:243]
    buffer_load_dwordx4 v9, s[36:39], s66 offen offset:0 sc1 lds
    buffer_load_dwordx4 v10, s[36:39], s66 offen offset:1024 sc1 lds
    buffer_load_dwordx4 v11, s[36:39], s66 offen offset:2048 sc1 lds
    v_mfma_f32_16x16x32_bf16 v[244:247], v[176:179], a[84:87], v[244:247]
    ds_read_b128 v[204:207], v0 offset:11264
    ds_read_b128 v[176:179], v0 offset:12288
    v_mfma_f32_16x16x32_bf16 v[248:251], v[180:183], a[80:83], v[248:251]
    s_waitcnt lgkmcnt(2)
    v_max3_u32 v44, v32, v34, v36
    v_mfma_f32_16x16x32_bf16 v[252:255], v[180:183], a[84:87], v[252:255]
    ds_read_b128 v[180:183], v0 offset:13312
    v_max3_u32 v38, v38, v40, v42
    v_mfma_f32_16x16x32_bf16 v[208:211], v[184:187], a[88:91], v[208:211]
    v_max_u32 v44, v44, v38
    v_mfma_f32_16x16x32_bf16 v[212:215], v[184:187], a[92:95], v[212:215]
    ds_read_b128 v[184:187], v0 offset:14336
    v_cmp_eq_u32 vcc, -1, v44
    v_mfma_f32_16x16x32_bf16 v[216:219], v[188:191], a[88:91], v[216:219]
    s_cbranch_vccnz L_s_gs7
L_s_gb7:
    s_barrier
    v_mfma_f32_16x16x32_bf16 v[220:223], v[188:191], a[92:95], v[220:223]
    ds_read_b128 v[188:191], v0 offset:15360
    v_mfma_f32_16x16x32_bf16 v[224:227], v[192:195], a[88:91], v[224:227]
    v_mfma_f32_16x16x32_bf16 v[228:231], v[192:195], a[92:95], v[228:231]
    ds_read_b128 v[192:195], v0 offset:16384
    v_mfma_f32_16x16x32_bf16 v[232:235], v[196:199], a[88:91], v[232:235]
    v_mfma_f32_16x16x32_bf16 v[236:239], v[196:199], a[92:95], v[236:239]
    ds_read_b128 v[196:199], v0 offset:17408
    v_mfma_f32_16x16x32_bf16 v[240:243], v[200:203], a[88:91], v[240:243]
    v_mfma_f32_16x16x32_bf16 v[244:247], v[200:203], a[92:95], v[244:247]
    ds_read_b128 v[200:203], v0 offset:18432
    s_waitcnt lgkmcnt(4)
    v_mfma_f32_16x16x32_bf16 v[248:251], v[204:207], a[88:91], v[248:251]
    v_mfma_f32_16x16x32_bf16 v[252:255], v[204:207], a[92:95], v[252:255]
    ds_read_b128 v[204:207], v0 offset:19456
    v_mfma_f32_16x16x32_bf16 v[208:211], v[176:179], a[96:99], v[208:211]
    v_mfma_f32_16x16x32_bf16 v[212:215], v[176:179], a[100:103], v[212:215]
    ds_read_b128 v[176:179], v0 offset:20480
    v_mfma_f32_16x16x32_bf16 v[216:219], v[180:183], a[96:99], v[216:219]
    v_mfma_f32_16x16x32_bf16 v[220:223], v[180:183], a[100:103], v[220:223]
    ds_read_b128 v[180:183], v0 offset:21504
    v_mfma_f32_16x16x32_bf16 v[224:227], v[184:187], a[96:99], v[224:227]
    v_mfma_f32_16x16x32_bf16 v[228:231], v[184:187], a[100:103], v[228:231]
    ds_read_b128 v[184:187], v0 offset:22528
    s_waitcnt lgkmcnt(4)
    v_mfma_f32_16x16x32_bf16 v[232:235], v[188:191], a[96:99], v[232:235]
    v_mfma_f32_16x16x32_bf16 v[236:239], v[188:191], a[100:103], v[236:239]
    ds_read_b128 v[188:191], v0 offset:23552
    v_mfma_f32_16x16x32_bf16 v[240:243], v[192:195], a[96:99], v[240:243]
    v_mfma_f32_16x16x32_bf16 v[244:247], v[192:195], a[100:103], v[244:247]
    ds_read_b128 v[192:195], v0 offset:24576
    v_mfma_f32_16x16x32_bf16 v[248:251], v[196:199], a[96:99], v[248:251]
    v_mfma_f32_16x16x32_bf16 v[252:255], v[196:199], a[100:103], v[252:255]
    ds_read_b128 v[196:199], v0 offset:25600
    v_mfma_f32_16x16x32_bf16 v[208:211], v[200:203], a[104:107], v[208:211]
    v_mfma_f32_16x16x32_bf16 v[212:215], v[200:203], a[108:111], v[212:215]
    ds_read_b128 v[200:203], v0 offset:26624
    s_waitcnt lgkmcnt(4)
    v_mfma_f32_16x16x32_bf16 v[216:219], v[204:207], a[104:107], v[216:219]
    v_mfma_f32_16x16x32_bf16 v[220:223], v[204:207], a[108:111], v[220:223]
    ds_read_b128 v[204:207], v0 offset:27648
    s_waitcnt vmcnt(3)
    ds_read_b128 v[32:35], v14 offset:36864
    v_mfma_f32_16x16x32_bf16 v[224:227], v[176:179], a[104:107], v[224:227]
    ds_read_b128 v[36:39], v14 offset:37888
    ds_read_b128 v[40:43], v14 offset:38912
    v_mfma_f32_16x16x32_bf16 v[228:231], v[176:179], a[108:111], v[228:231]
    ds_read_b128 v[176:179], v0 offset:28672
    v_mfma_f32_16x16x32_bf16 v[232:235], v[180:183], a[104:107], v[232:235]
    v_mfma_f32_16x16x32_bf16 v[236:239], v[180:183], a[108:111], v[236:239]
    ds_read_b128 v[180:183], v0 offset:29696
    v_mfma_f32_16x16x32_bf16 v[240:243], v[184:187], a[104:107], v[240:243]
    v_mfma_f32_16x16x32_bf16 v[244:247], v[184:187], a[108:111], v[244:247]
    ds_read_b128 v[184:187], v0 offset:30720
    s_waitcnt lgkmcnt(7)
    v_mfma_f32_16x16x32_bf16 v[248:251], v[188:191], a[104:107], v[248:251]
    v_mfma_f32_16x16x32_bf16 v[252:255], v[188:191], a[108:111], v[252:255]
    ds_read_b128 v[188:191], v0 offset:31744
    v_mfma_f32_16x16x32_bf16 v[208:211], v[192:195], a[112:115], v[208:211]
    v_mfma_f32_16x16x32_bf16 v[212:215], v[192:195], a[116:119], v[212:215]
    ds_read_b128 v[192:195], v0 offset:32768
    s_waitcnt lgkmcnt(5)
    v_max3_u32 v44, v32, v34, v36
    v_mfma_f32_16x16x32_bf16 v[216:219], v[196:199], a[112:115], v[216:219]
    v_max3_u32 v38, v38, v40, v42
    v_mfma_f32_16x16x32_bf16 v[220:223], v[196:199], a[116:119], v[220:223]
    ds_read_b128 v[196:199], v0 offset:33792
    v_max_u32 v44, v44, v38
    v_mfma_f32_16x16x32_bf16 v[224:227], v[200:203], a[112:115], v[224:227]
    v_cmp_eq_u32 vcc, -1, v44
    v_mfma_f32_16x16x32_bf16 v[228:231], v[200:203], a[116:119], v[228:231]
    ds_read_b128 v[200:203], v0 offset:34816
    v_mfma_f32_16x16x32_bf16 v[232:235], v[204:207], a[112:115], v[232:235]
    s_cbranch_vccnz L_s_gs8
L_s_gb8:
    s_barrier
    v_mfma_f32_16x16x32_bf16 v[236:239], v[204:207], a[116:119], v[236:239]
    ds_read_b128 v[204:207], v0 offset:35840
    s_waitcnt vmcnt(0)
    ds_read_b128 v[32:35], v14 offset:49152
    s_waitcnt lgkmcnt(4)
    v_mfma_f32_16x16x32_bf16 v[240:243], v[176:179], a[112:115], v[240:243]
    ds_read_b128 v[36:39], v14 offset:50176
    ds_read_b128 v[40:43], v14 offset:51200
    v_mfma_f32_16x16x32_bf16 v[244:247], v[176:179], a[116:119], v[244:247]
    ds_read_b128 v[176:179], v0 offset:36864
    v_mfma_f32_16x16x32_bf16 v[248:251], v[180:183], a[112:115], v[248:251]
    v_mfma_f32_16x16x32_bf16 v[252:255], v[180:183], a[116:119], v[252:255]
    ds_read_b128 v[180:183], v0 offset:37888
    v_mfma_f32_16x16x32_bf16 v[208:211], v[184:187], a[120:123], v[208:211]
    v_mfma_f32_16x16x32_bf16 v[212:215], v[184:187], a[124:127], v[212:215]
    ds_read_b128 v[184:187], v0 offset:38912
    v_mfma_f32_16x16x32_bf16 v[216:219], v[188:191], a[120:123], v[216:219]
    v_mfma_f32_16x16x32_bf16 v[220:223], v[188:191], a[124:127], v[220:223]
    ds_read_b128 v[188:191], v0 offset:39936
    v_mfma_f32_16x16x32_bf16 v[224:227], v[192:195], a[120:123], v[224:227]
    s_waitcnt lgkmcnt(4)
    v_max3_u32 v44, v32, v34, v36
    v_mfma_f32_16x16x32_bf16 v[228:231], v[192:195], a[124:127], v[228:231]
    ds_read_b128 v[192:195], v0 offset:43008
    v_max3_u32 v38, v38, v40, v42
    v_mfma_f32_16x16x32_bf16 v[232:235], v[196:199], a[120:123], v[232:235]
    v_max_u32 v44, v44, v38
    v_mfma_f32_16x16x32_bf16 v[236:239], v[196:199], a[124:127], v[236:239]
    ds_read_b128 v[196:199], v0 offset:44032
    v_cmp_eq_u32 vcc, -1, v44
    v_mfma_f32_16x16x32_bf16 v[240:243], v[200:203], a[120:123], v[240:243]
    s_cbranch_vccnz L_s_gs9
L_s_gb9:
    s_barrier
    v_mfma_f32_16x16x32_bf16 v[244:247], v[200:203], a[124:127], v[244:247]
    ds_read_b128 v[200:203], v0 offset:45056
    v_mfma_f32_16x16x32_bf16 v[248:251], v[204:207], a[120:123], v[248:251]
    v_mfma_f32_16x16x32_bf16 v[252:255], v[204:207], a[124:127], v[252:255]
    ds_read_b128 v[204:207], v0 offset:46080
    s_waitcnt lgkmcnt(4)
    v_mfma_f32_16x16x32_bf16 v[208:211], v[176:179], a[128:131], v[208:211]
    v_mfma_f32_16x16x32_bf16 v[212:215], v[176:179], a[132:135], v[212:215]
    ds_read_b128 v[176:179], v0 offset:49152
    v_mfma_f32_16x16x32_bf16 v[216:219], v[180:183], a[128:131], v[216:219]
    v_mfma_f32_16x16x32_bf16 v[220:223], v[180:183], a[132:135], v[220:223]
    ds_read_b128 v[180:183], v0 offset:50176
    v_mfma_f32_16x16x32_bf16 v[224:227], v[184:187], a[128:131], v[224:227]
    v_mfma_f32_16x16x32_bf16 v[228:231], v[184:187], a[132:135], v[228:231]
    ds_read_b128 v[184:187], v0 offset:51200
    v_mfma_f32_16x16x32_bf16 v[232:235], v[188:191], a[128:131], v[232:235]
    v_mfma_f32_16x16x32_bf16 v[236:239], v[188:191], a[132:135], v[236:239]
    ds_read_b128 v[188:191], v0 offset:52224
    s_waitcnt lgkmcnt(4)
    v_mfma_f32_16x16x32_bf16 v[208:211], v[192:195], a[136:139], v[208:211]
    v_mfma_f32_16x16x32_bf16 v[212:215], v[192:195], a[140:143], v[212:215]
    ds_read_b128 v[192:195], v0 offset:55296
    v_mfma_f32_16x16x32_bf16 v[216:219], v[196:199], a[136:139], v[216:219]
    v_mfma_f32_16x16x32_bf16 v[220:223], v[196:199], a[140:143], v[220:223]
    ds_read_b128 v[196:199], v0 offset:56320
    v_mfma_f32_16x16x32_bf16 v[224:227], v[200:203], a[136:139], v[224:227]
    v_mfma_f32_16x16x32_bf16 v[228:231], v[200:203], a[140:143], v[228:231]
    ds_read_b128 v[200:203], v0 offset:57344
    v_mfma_f32_16x16x32_bf16 v[232:235], v[204:207], a[136:139], v[232:235]
    v_mfma_f32_16x16x32_bf16 v[236:239], v[204:207], a[140:143], v[236:239]
    ds_read_b128 v[204:207], v0 offset:58368
    s_waitcnt lgkmcnt(4)
    v_mfma_f32_16x16x32_bf16 v[208:211], v[176:179], a[144:147], v[208:211]
    v_mfma_f32_16x16x32_bf16 v[212:215], v[176:179], a[148:151], v[212:215]
    ds_read_b128 v[176:179], v0 offset:40960
    v_mfma_f32_16x16x32_bf16 v[216:219], v[180:183], a[144:147], v[216:219]
    v_mfma_f32_16x16x32_bf16 v[220:223], v[180:183], a[148:151], v[220:223]
    ds_read_b128 v[180:183], v0 offset:41984
    v_mfma_f32_16x16x32_bf16 v[224:227], v[184:187], a[144:147], v[224:227]
    v_mfma_f32_16x16x32_bf16 v[228:231], v[184:187], a[148:151], v[228:231]
    ds_read_b128 v[184:187], v0 offset:47104
    v_mfma_f32_16x16x32_bf16 v[232:235], v[188:191], a[144:147], v[232:235]
    v_mfma_f32_16x16x32_bf16 v[236:239], v[188:191], a[148:151], v[236:239]
    ds_read_b128 v[188:191], v0 offset:48128
    s_waitcnt lgkmcnt(4)
    v_mfma_f32_16x16x32_bf16 v[208:211], v[192:195], a[152:155], v[208:211]
    v_mfma_f32_16x16x32_bf16 v[212:215], v[192:195], a[156:159], v[212:215]
    ds_read_b128 v[192:195], v0 offset:53248
    v_mfma_f32_16x16x32_bf16 v[216:219], v[196:199], a[152:155], v[216:219]
    v_cvt_pk_bf16_f32 v148, v208, v209
    v_cvt_pk_bf16_f32 v149, v210, v211
    v_mfma_f32_16x16x32_bf16 v[220:223], v[196:199], a[156:159], v[220:223]
    ds_read_b128 v[196:199], v0 offset:54272
    v_mfma_f32_16x16x32_bf16 v[224:227], v[200:203], a[152:155], v[224:227]
    v_cvt_pk_bf16_f32 v150, v216, v217
    v_cvt_pk_bf16_f32 v151, v218, v219
    s_nop 0
    v_permlane16_swap_b32 v148, v150
    v_permlane16_swap_b32 v149, v151
    buffer_store_dwordx4 v[148:151], v7, s[40:43], 0 offen offset:0 nt
    v_cvt_pk_bf16_f32 v152, v212, v213
    v_cvt_pk_bf16_f32 v153, v214, v215
    v_cvt_pk_bf16_f32 v154, v220, v221
    v_cvt_pk_bf16_f32 v155, v222, v223
    s_nop 0
    v_permlane16_swap_b32 v152, v154
    v_permlane16_swap_b32 v153, v155
    buffer_store_dwordx4 v[152:155], v8, s[40:43], 0 offen offset:0 nt
    v_cvt_pk_bf16_f32 v156, v224, v225
    v_cvt_pk_bf16_f32 v157, v226, v227
    v_mfma_f32_16x16x32_bf16 v[228:231], v[200:203], a[156:159], v[228:231]
    ds_read_b128 v[200:203], v0 offset:59392
    v_mfma_f32_16x16x32_bf16 v[232:235], v[204:207], a[152:155], v[232:235]
    v_mfma_f32_16x16x32_bf16 v[236:239], v[204:207], a[156:159], v[236:239]
    ds_read_b128 v[204:207], v0 offset:60416
    s_waitcnt lgkmcnt(2)
    v_mfma_f32_16x16x32_bf16 v[240:243], v[176:179], a[128:131], v[240:243]
    v_cvt_pk_bf16_f32 v158, v232, v233
    v_cvt_pk_bf16_f32 v159, v234, v235
    s_nop 0
    v_permlane16_swap_b32 v156, v158
    v_permlane16_swap_b32 v157, v159
    buffer_store_dwordx4 v[156:159], v7, s[40:43], 0 offen offset:64 nt
    v_cvt_pk_bf16_f32 v160, v228, v229
    v_cvt_pk_bf16_f32 v161, v230, v231
    v_cvt_pk_bf16_f32 v162, v236, v237
    v_cvt_pk_bf16_f32 v163, v238, v239
    s_nop 0
    v_permlane16_swap_b32 v160, v162
    v_permlane16_swap_b32 v161, v163
    buffer_store_dwordx4 v[160:163], v8, s[40:43], 0 offen offset:64 nt
    v_mfma_f32_16x16x32_bf16 v[244:247], v[176:179], a[132:135], v[244:247]
    v_mfma_f32_16x16x32_bf16 v[248:251], v[180:183], a[128:131], v[248:251]
    v_mfma_f32_16x16x32_bf16 v[252:255], v[180:183], a[132:135], v[252:255]
    v_mfma_f32_16x16x32_bf16 v[240:243], v[184:187], a[136:139], v[240:243]
    v_mfma_f32_16x16x32_bf16 v[244:247], v[184:187], a[140:143], v[244:247]
    v_mfma_f32_16x16x32_bf16 v[248:251], v[188:191], a[136:139], v[248:251]
    v_mfma_f32_16x16x32_bf16 v[252:255], v[188:191], a[140:143], v[252:255]
    v_mfma_f32_16x16x32_bf16 v[240:243], v[192:195], a[144:147], v[240:243]
    v_mfma_f32_16x16x32_bf16 v[244:247], v[192:195], a[148:151], v[244:247]
    v_mfma_f32_16x16x32_bf16 v[248:251], v[196:199], a[144:147], v[248:251]
    v_mfma_f32_16x16x32_bf16 v[252:255], v[196:199], a[148:151], v[252:255]
    s_waitcnt lgkmcnt(0)
    v_mfma_f32_16x16x32_bf16 v[240:243], v[200:203], a[152:155], v[240:243]
    v_mfma_f32_16x16x32_bf16 v[244:247], v[200:203], a[156:159], v[244:247]
    v_mfma_f32_16x16x32_bf16 v[248:251], v[204:207], a[152:155], v[248:251]
    v_cvt_pk_bf16_f32 v164, v240, v241
    v_cvt_pk_bf16_f32 v165, v242, v243
    v_mfma_f32_16x16x32_bf16 v[252:255], v[204:207], a[156:159], v[252:255]
    s_nop 3
    v_cvt_pk_bf16_f32 v166, v248, v249
    v_cvt_pk_bf16_f32 v167, v250, v251
    s_nop 0
    v_permlane16_swap_b32 v164, v166
    v_permlane16_swap_b32 v165, v167
    buffer_store_dwordx4 v[164:167], v7, s[40:43], 0 offen offset:128 nt
    v_cvt_pk_bf16_f32 v168, v244, v245
    v_cvt_pk_bf16_f32 v169, v246, v247
    v_cvt_pk_bf16_f32 v170, v252, v253
    v_cvt_pk_bf16_f32 v171, v254, v255
    s_nop 0
    v_permlane16_swap_b32 v168, v170
    v_permlane16_swap_b32 v169, v171
    buffer_store_dwordx4 v[168:171], v8, s[40:43], 0 offen offset:128 nt
    s_endpgm
L_s_sl1:
    s_mov_b32 s54, 0
L_s_sl1l:
    s_add_u32 s54, s54, 1
    s_cmp_gt_u32 s54, 30000
    s_cbranch_scc1 L_s_bk1
    global_load_dword v24, v25, s[18:19] sc1
    s_waitcnt vmcnt(0)
    v_cmp_ne_u32 vcc, 1, v24
    s_cmp_lg_u64 vcc, 0
    s_cbranch_scc1 L_s_sl1l
    s_branch L_s_bk1
L_s_sl2:
    s_mov_b32 s54, 0
L_s_sl2l:
    s_add_u32 s54, s54, 1
    s_cmp_gt_u32 s54, 30000
    s_cbranch_scc1 L_s_bk2
    buffer_load_dword v23, v19, s[36:39], s13 offen sc1
    s_waitcnt vmcnt(0)
    v_cmp_ne_u32 vcc, 1, v23
    s_cmp_lg_u64 vcc, 0
    s_cbranch_scc1 L_s_sl2l
    s_branch L_s_bk2
L_s_sl3:
    s_mov_b32 s54, 0
L_s_sl3l:
    s_add_u32 s54, s54, 1
    s_cmp_gt_u32 s54, 30000
    s_cbranch_scc1 L_s_bk3
    buffer_load_dword v22, v17, s[36:39], s14 offen sc1
    s_waitcnt vmcnt(0)
    v_cmp_ne_u32 vcc, 1, v22
    s_cmp_lg_u64 vcc, 0
    s_cbranch_scc1 L_s_sl3l
    s_branch L_s_bk3
L_s_gs0:
    s_mov_b32 s54, 0
    s_mov_b32 s52, m0
    s_add_u32 m0, s22, 0
L_s_gs0l:
    s_add_u32 s54, s54, 1
    s_cmp_gt_u32 s54, 30000
    s_cbranch_scc1 L_s_gs0x
    buffer_load_dwordx4 v9, s[36:39], s57 offen offset:0 sc1 lds
    buffer_load_dwordx4 v10, s[36:39], s57 offen offset:1024 sc1 lds
    buffer_load_dwordx4 v11, s[36:39], s57 offen offset:2048 sc1 lds
    s_waitcnt vmcnt(0)
    ds_read_b128 v[32:35], v13 offset:0
    ds_read_b128 v[36:39], v13 offset:1024
    ds_read_b128 v[40:43], v13 offset:2048
    s_waitcnt lgkmcnt(0)
    v_max3_u32 v44, v32, v34, v36
    v_max3_u32 v38, v38, v40, v42
    v_max_u32 v44, v44, v38
    v_cmp_eq_u32 vcc, -1, v44
    s_nop 1
    s_cbranch_vccnz L_s_gs0l
L_s_gs0x:
    s_mov_b32 m0, s52
    s_branch L_s_gb0
L_s_gs1:
    s_mov_b32 s54, 0
    s_mov_b32 s52, m0
    s_add_u32 m0, s22, 12288
L_s_gs1l:
    s_add_u32 s54, s54, 1
    s_cmp_gt_u32 s54, 30000
    s_cbranch_scc1 L_s_gs1x
    buffer_load_dwordx4 v9, s[36:39], s58 offen offset:0 sc1 lds
    buffer_load_dwordx4 v10, s[36:39], s58 offen offset:1024 sc1 lds
    buffer_load_dwordx4 v11, s[36:39], s58 offen offset:2048 sc1 lds
    s_waitcnt vmcnt(0)
    ds_read_b128 v[32:35], v13 offset:12288
    ds_read_b128 v[36:39], v13 offset:13312
    ds_read_b128 v[40:43], v13 offset:14336
    s_waitcnt lgkmcnt(0)
    v_max3_u32 v44, v32, v34, v36
    v_max3_u32 v38, v38, v40, v42
    v_max_u32 v44, v44, v38
    v_cmp_eq_u32 vcc, -1, v44
    s_nop 1
    s_cbranch_vccnz L_s_gs1l
L_s_gs1x:
    s_mov_b32 m0, s52
    s_branch L_s_gb1
L_s_gs2:
    s_mov_b32 s54, 0
    s_mov_b32 s52, m0
    s_add_u32 m0, s22, 24576
L_s_gs2l:
    s_add_u32 s54, s54, 1
    s_cmp_gt_u32 s54, 30000
    s_cbranch_scc1 L_s_gs2x
    buffer_load_dwordx4 v9, s[36:39], s59 offen offset:0 sc1 lds
    buffer_load_dwordx4 v10, s[36:39], s59 offen offset:1024 sc1 lds
    buffer_load_dwordx4 v11, s[36:39], s59 offen offset:2048 sc1 lds
    s_waitcnt vmcnt(0)
    ds_read_b128 v[32:35], v13 offset:24576
    ds_read_b128 v[36:39], v13 offset:25600
    ds_read_b128 v[40:43], v13 offset:26624
    s_waitcnt lgkmcnt(0)
    v_max3_u32 v44, v32, v34, v36
    v_max3_u32 v38, v38, v40, v42
    v_max_u32 v44, v44, v38
    v_cmp_eq_u32 vcc, -1, v44
    s_nop 1
    s_cbranch_vccnz L_s_gs2l
L_s_gs2x:
    s_mov_b32 m0, s52
    s_branch L_s_gb2
L_s_gs3:
    s_mov_b32 s54, 0
    s_mov_b32 s52, m0
    s_add_u32 m0, s22, 36864
L_s_gs3l:
    s_add_u32 s54, s54, 1
    s_cmp_gt_u32 s54, 30000
    s_cbranch_scc1 L_s_gs3x
    buffer_load_dwordx4 v9, s[36:39], s60 offen offset:0 sc1 lds
    buffer_load_dwordx4 v10, s[36:39], s60 offen offset:1024 sc1 lds
    buffer_load_dwordx4 v11, s[36:39], s60 offen offset:2048 sc1 lds
    s_waitcnt vmcnt(0)
    ds_read_b128 v[32:35], v13 offset:36864
    ds_read_b128 v[36:39], v13 offset:37888
    ds_read_b128 v[40:43], v13 offset:38912
    s_waitcnt lgkmcnt(0)
    v_max3_u32 v44, v32, v34, v36
    v_max3_u32 v38, v38, v40, v42
    v_max_u32 v44, v44, v38
    v_cmp_eq_u32 vcc, -1, v44
    s_nop 1
    s_cbranch_vccnz L_s_gs3l
L_s_gs3x:
    s_mov_b32 m0, s52
    s_branch L_s_gb3
L_s_gs4:
    s_mov_b32 s54, 0
    s_mov_b32 s52, m0
    s_add_u32 m0, s22, 49152
L_s_gs4l:
    s_add_u32 s54, s54, 1
    s_cmp_gt_u32 s54, 30000
    s_cbranch_scc1 L_s_gs4x
    buffer_load_dwordx4 v9, s[36:39], s61 offen offset:0 sc1 lds
    buffer_load_dwordx4 v10, s[36:39], s61 offen offset:1024 sc1 lds
    buffer_load_dwordx4 v11, s[36:39], s61 offen offset:2048 sc1 lds
    s_waitcnt vmcnt(0)
    ds_read_b128 v[32:35], v13 offset:49152
    ds_read_b128 v[36:39], v13 offset:50176
    ds_read_b128 v[40:43], v13 offset:51200
    s_waitcnt lgkmcnt(0)
    v_max3_u32 v44, v32, v34, v36
    v_max3_u32 v38, v38, v40, v42
    v_max_u32 v44, v44, v38
    v_cmp_eq_u32 vcc, -1, v44
    s_nop 1
    s_cbranch_vccnz L_s_gs4l
L_s_gs4x:
    s_mov_b32 m0, s52
    s_branch L_s_gb4
L_s_gs5:
    s_mov_b32 s54, 0
    s_mov_b32 s52, m0
    s_add_u32 m0, s22, 61440
L_s_gs5l:
    s_add_u32 s54, s54, 1
    s_cmp_gt_u32 s54, 30000
    s_cbranch_scc1 L_s_gs5x
    buffer_load_dwordx4 v9, s[36:39], s62 offen offset:0 sc1 lds
    buffer_load_dwordx4 v10, s[36:39], s62 offen offset:1024 sc1 lds
    buffer_load_dwordx4 v11, s[36:39], s62 offen offset:2048 sc1 lds
    s_waitcnt vmcnt(0)
    ds_read_b128 v[32:35], v14 offset:0
    ds_read_b128 v[36:39], v14 offset:1024
    ds_read_b128 v[40:43], v14 offset:2048
    s_waitcnt lgkmcnt(0)
    v_max3_u32 v44, v32, v34, v36
    v_max3_u32 v38, v38, v40, v42
    v_max_u32 v44, v44, v38
    v_cmp_eq_u32 vcc, -1, v44
    s_nop 1
    s_cbranch_vccnz L_s_gs5l
L_s_gs5x:
    s_mov_b32 m0, s52
    s_branch L_s_gb5
L_s_gs6:
    s_mov_b32 s54, 0
    s_mov_b32 s52, m0
    s_add_u32 m0, s22, 73728
L_s_gs6l:
    s_add_u32 s54, s54, 1
    s_cmp_gt_u32 s54, 30000
    s_cbranch_scc1 L_s_gs6x
    buffer_load_dwordx4 v9, s[36:39], s63 offen offset:0 sc1 lds
    buffer_load_dwordx4 v10, s[36:39], s63 offen offset:1024 sc1 lds
    buffer_load_dwordx4 v11, s[36:39], s63 offen offset:2048 sc1 lds
    s_waitcnt vmcnt(0)
    ds_read_b128 v[32:35], v14 offset:12288
    ds_read_b128 v[36:39], v14 offset:13312
    ds_read_b128 v[40:43], v14 offset:14336
    s_waitcnt lgkmcnt(0)
    v_max3_u32 v44, v32, v34, v36
    v_max3_u32 v38, v38, v40, v42
    v_max_u32 v44, v44, v38
    v_cmp_eq_u32 vcc, -1, v44
    s_nop 1
    s_cbranch_vccnz L_s_gs6l
L_s_gs6x:
    s_mov_b32 m0, s52
    s_branch L_s_gb6
L_s_gs7:
    s_mov_b32 s54, 0
    s_mov_b32 s52, m0
    s_add_u32 m0, s22, 86016
L_s_gs7l:
    s_add_u32 s54, s54, 1
    s_cmp_gt_u32 s54, 30000
    s_cbranch_scc1 L_s_gs7x
    buffer_load_dwordx4 v9, s[36:39], s64 offen offset:0 sc1 lds
    buffer_load_dwordx4 v10, s[36:39], s64 offen offset:1024 sc1 lds
    buffer_load_dwordx4 v11, s[36:39], s64 offen offset:2048 sc1 lds
    s_waitcnt vmcnt(0)
    ds_read_b128 v[32:35], v14 offset:24576
    ds_read_b128 v[36:39], v14 offset:25600
    ds_read_b128 v[40:43], v14 offset:26624
    s_waitcnt lgkmcnt(0)
    v_max3_u32 v44, v32, v34, v36
    v_max3_u32 v38, v38, v40, v42
    v_max_u32 v44, v44, v38
    v_cmp_eq_u32 vcc, -1, v44
    s_nop 1
    s_cbranch_vccnz L_s_gs7l
L_s_gs7x:
    s_mov_b32 m0, s52
    s_branch L_s_gb7
L_s_gs8:
    s_mov_b32 s54, 0
    s_mov_b32 s52, m0
    s_add_u32 m0, s22, 98304
L_s_gs8l:
    s_add_u32 s54, s54, 1
    s_cmp_gt_u32 s54, 30000
    s_cbranch_scc1 L_s_gs8x
    buffer_load_dwordx4 v9, s[36:39], s65 offen offset:0 sc1 lds
    buffer_load_dwordx4 v10, s[36:39], s65 offen offset:1024 sc1 lds
    buffer_load_dwordx4 v11, s[36:39], s65 offen offset:2048 sc1 lds
    s_waitcnt vmcnt(0)
    ds_read_b128 v[32:35], v14 offset:36864
    ds_read_b128 v[36:39], v14 offset:37888
    ds_read_b128 v[40:43], v14 offset:38912
    s_waitcnt lgkmcnt(0)
    v_max3_u32 v44, v32, v34, v36
    v_max3_u32 v38, v38, v40, v42
    v_max_u32 v44, v44, v38
    v_cmp_eq_u32 vcc, -1, v44
    s_nop 1
    s_cbranch_vccnz L_s_gs8l
L_s_gs8x:
    s_mov_b32 m0, s52
    s_branch L_s_gb8
L_s_gs9:
    s_mov_b32 s54, 0
    s_mov_b32 s52, m0
    s_add_u32 m0, s22, 110592
L_s_gs9l:
    s_add_u32 s54, s54, 1
    s_cmp_gt_u32 s54, 30000
    s_cbranch_scc1 L_s_gs9x
    buffer_load_dwordx4 v9, s[36:39], s66 offen offset:0 sc1 lds
    buffer_load_dwordx4 v10, s[36:39], s66 offen offset:1024 sc1 lds
    buffer_load_dwordx4 v11, s[36:39], s66 offen offset:2048 sc1 lds
    s_waitcnt vmcnt(0)
    ds_read_b128 v[32:35], v14 offset:49152
    ds_read_b128 v[36:39], v14 offset:50176
    ds_read_b128 v[40:43], v14 offset:51200
    s_waitcnt lgkmcnt(0)
    v_max3_u32 v44, v32, v34, v36
    v_max3_u32 v38, v38, v40, v42
    v_max_u32 v44, v44, v38
    v_cmp_eq_u32 vcc, -1, v44
    s_nop 1
    s_cbranch_vccnz L_s_gs9l
L_s_gs9x:
    s_mov_b32 m0, s52
    s_branch L_s_gb9
L_exit:
    s_endpgm
L_code_end:
.section .rodata,"a"
.p2align 6
.amdhsa_kernel standalone__weight_only_int_quip__prompt_kernel
  .amdhsa_float_denorm_mode_32 3
  .amdhsa_next_free_vgpr 512
  .amdhsa_next_free_sgpr 102
  .amdhsa_accum_offset 256
  .amdhsa_group_segment_fixed_size 0
  .amdhsa_kernarg_size 72
  .amdhsa_user_sgpr_count 2
  .amdhsa_user_sgpr_kernarg_segment_ptr 1
  .amdhsa_system_sgpr_workgroup_id_x 1
.end_amdhsa_kernel
```
